```python
import torch

def _softmax(x, axis=-1):
    return torch.softmax(x, dim=axis)

def _gelu(x):
    return torch.nn.functional.gelu(x, approximate='tanh')

def _silu(x):
    return torch.nn.functional.silu(x)

def _sigmoid(x):
    return torch.sigmoid(x)

def _layernorm(x, axis=-1, eps=1e-05):
    m = x.mean(dim=axis, keepdim=True)
    v = x.var(dim=axis, keepdim=True, unbiased=False)
    return (x - m) / torch.sqrt(v + eps)

def _scatter_add(tgt, idx, src, axis=0):
    return tgt.clone().index_add_(axis, idx, src)

def _segment_sum(src, seg, n):
    out = torch.zeros((n,) + src.shape[1:], dtype=src.dtype)
    return out.index_add_(0, seg, src)

def _pad(x, pw):
    flat = tuple((v for pair in reversed(pw) for v in pair))
    return torch.nn.functional.pad(x, flat)
kernel_name = 'adaLN_cond__ssm_conv_s4d__glu_gated_swiglu__prompt'

def setup_inputs():

    _w = lambda a: (lambda t: t.to(torch.bfloat16) if t.is_floating_point() else t)(torch.as_tensor(a))

    def _A_setup():
        Bsz, L, D, N = (1, 2048, 448, 256)
        return {'u': _w((lambda *s: torch.randn(*s, dtype=torch.bfloat16) * 0.05)(Bsz, L, D)), 'log_A_real': _w((lambda *s: torch.randn(*s, dtype=torch.bfloat16) * 3.2)(D, N) * 0.5), 'A_imag': _w((lambda *s: torch.randn(*s, dtype=torch.bfloat16) * 0.05)(D, N) * 3.14), 'C_real': _w((lambda *s: torch.randn(*s, dtype=torch.bfloat16) * 0.2)(D, N) / N ** 0.5), 'C_imag': _w((lambda *s: torch.randn(*s, dtype=torch.bfloat16) * 0.2)(D, N) / N ** 0.5), 'log_dt': _w((lambda *s: torch.randn(*s, dtype=torch.bfloat16) * 0.05)(D) * 0.5 - 4.0), 'D_skip': _w((lambda *s: torch.randn(*s, dtype=torch.bfloat16) * 0.05)(D))}
    _A_in = _A_setup()

    def _B_setup():
        B, S, D, F = (1, 2048, 448, 1792)
        return {'x': _w((lambda *s: torch.randn(*s, dtype=torch.bfloat16) * 0.05)(B, S, D)), 'w1': _w((lambda *s: torch.randn(*s, dtype=torch.bfloat16) * 0.4)(D, F) * (2.0 / D) ** 0.5), 'w3': _w((lambda *s: torch.randn(*s, dtype=torch.bfloat16) * 0.4)(D, F) * (2.0 / D) ** 0.5), 'w2': _w((lambda *s: torch.randn(*s, dtype=torch.bfloat16) * 0.4)(F, D) * (2.0 / F) ** 0.5)}
    _B_in = _B_setup()
    return {'A_u': _A_in['u'], 'A_log_A_real': _A_in['log_A_real'], 'A_A_imag': _A_in['A_imag'], 'A_C_real': _A_in['C_real'], 'A_C_imag': _A_in['C_imag'], 'A_log_dt': _A_in['log_dt'], 'A_D_skip': _A_in['D_skip'], 'B_x': _B_in['x'], 'B_w1': _B_in['w1'], 'B_w3': _B_in['w3'], 'B_w2': _B_in['w2'], 'c': _w((lambda *s: torch.randn(*s, dtype=torch.bfloat16) * 0.4)(1, 448) * 8.0), 'w_mod': _w((lambda *s: torch.randn(*s, dtype=torch.bfloat16) * 0.4)(448, 6 * 448) * 448 ** (-0.5) * 8.0)}

def reference(A_u, A_log_A_real, A_A_imag, A_C_real, A_C_imag, A_log_dt, A_D_skip, B_x, B_w1, B_w3, B_w2, c, w_mod):

    def _A_ref(u, log_A_real, A_imag, C_real, C_imag, log_dt, D_skip):
        L = u.shape[1]
        dt = torch.exp(log_dt)
        A = -torch.exp(log_A_real) + 1j * A_imag
        C = (C_real + 1j * C_imag) * dt[:, None]
        pos = (lambda x, dt: x.to(dt))(torch.arange(L), log_dt.dtype)
        P = torch.exp((A * dt[:, None])[:, :, None] * pos[None, None, :])
        K = 2.0 * torch.einsum('dn,dnl->dl', C, P).real
        L2 = 2 * L
        u_t = (lambda x, *d: x.permute(*d))(u, 0, 2, 1)
        Kf = (lambda x, *a, **k: torch.fft.rfft(x.float(), *a, **k))(K, L2)
        Uf = (lambda x, *a, **k: torch.fft.rfft(x.float(), *a, **k))(u_t, L2)
        y = (lambda x, *a, **k: torch.fft.irfft(x, *a, **k).to(torch.bfloat16))(Uf * Kf[None, :, :], L2)[:, :, :L]
        y = (lambda x, *d: x.permute(*d))(y, 0, 2, 1)
        return y + u * D_skip[None, None, :]

    def _B_ref(x, w1, w3, w2):
        gate = torch.einsum('bsd,df->bsf', x, w1)
        up = torch.einsum('bsd,df->bsf', x, w3)
        h = _silu(gate) * up
        out = torch.einsum('bsf,fd->bsd', h, w2)
        return out
    x = A_u
    mod = (_silu(c) @ w_mod).reshape(c.shape[0], 6, 1, -1)
    sa, ca, ga, sb, cb, gb = (mod[:, 0].clone(), mod[:, 1].clone(), mod[:, 2].clone(), mod[:, 3].clone(), mod[:, 4].clone(), mod[:, 5].clone())
    h = _layernorm(x, axis=-1) * (1 + ca) + sa
    x = x + ga * _A_ref(h, A_log_A_real, A_A_imag, A_C_real, A_C_imag, A_log_dt, A_D_skip)
    h = _layernorm(x, axis=-1) * (1 + cb) + sb
    x = x + gb * _B_ref(h, B_w1, B_w3, B_w2)
    return x
```

```asm
; @launch grid=(256,1,1) block=(512,1,1) lds=163840
.amdgcn_target "amdgcn-amd-amdhsa--gfx950"
.text
.globl adaLN_cond__ssm_conv_s4d__glu_gated_swiglu__prompt_kernel
.p2align 8
.type adaLN_cond__ssm_conv_s4d__glu_gated_swiglu__prompt_kernel,@function
adaLN_cond__ssm_conv_s4d__glu_gated_swiglu__prompt_kernel:
  s_cmp_ge_u32 s2, 256
  s_cbranch_scc1 K_END
  s_load_dwordx16 s[4:19], s[0:1], 0
  s_load_dwordx4 s[20:23], s[0:1], 64
  s_load_dwordx2 s[24:25], s[0:1], 80
  s_load_dwordx4 s[72:75], s[0:1], 88
  s_load_dwordx4 s[68:71], s[0:1], 104
  s_load_dwordx2 s[26:27], s[0:1], 120
  v_lshrrev_b32 v1, 6, v0
  v_and_b32 v2, 63, v0
  v_readfirstlane_b32 s3, v1
  v_lshlrev_b32 v3, 4, v2
  s_lshl_b32 s36, s2, 3
  s_add_u32 s36, s36, s3
  s_mul_i32 s37, s36, 896
  v_mov_b32 v22, 0
  v_mov_b32 v24, 0
  v_mov_b32 v25, 0
  v_mov_b32 v26, 0
  v_mov_b32 v27, 0
  v_mov_b32 v28, 159744
  ds_write_b128 v28, v[24:27]
  ds_write_b128 v28, v[24:27] offset:16
  ds_write_b128 v28, v[24:27] offset:32
  ds_write_b128 v28, v[24:27] offset:48
  s_waitcnt lgkmcnt(0)
  s_mov_b32 s28, s26
  s_and_b32 s29, s27, 0xffff
  s_mov_b32 s30, 33554432
  s_mov_b32 s31, 0x20000
  s_mov_b32 s32, s70
  s_and_b32 s33, s71, 0xffff
  s_mov_b32 s34, 256
  s_mov_b32 s35, 0x20000
  s_add_u32 s40, s4, s37
  s_addc_u32 s41, s5, 0
  s_and_b32 s41, s41, 0xffff
  s_mov_b32 s42, 896
  s_mov_b32 s43, 0x20000
  buffer_load_dwordx4 v[184:187], v3, s[40:43], 0 offen
  s_cmp_lg_u32 s3, 7
  s_cbranch_scc1 A_NOPF
  s_getpc_b64 s[38:39]
  s_and_b32 s38, s38, 0xffffff00
  s_lshr_b32 s37, s2, 3
  s_lshl_b32 s37, s37, 10
  v_add_u32 v197, s37, v3
  v_mov_b32 v199, s39
  v_add_co_u32 v198, vcc, s38, v197
  s_nop 1
  v_addc_co_u32 v199, vcc, 0, v199, vcc
  global_load_dwordx4 v[216:219], v[198:199], off
A_NOPF:
  s_cmp_ge_u32 s2, 224
  s_cbranch_scc1 T_ENTRY
  s_and_b32 s44, s2, 7
  s_mul_i32 s44, s44, 28
  s_lshr_b32 s45, s2, 3
  s_add_u32 s44, s44, s45
  s_lshr_b32 s45, s3, 2
  s_and_b32 s46, s3, 3
  s_lshl_b32 s47, s44, 1
  s_add_u32 s47, s47, s45
  s_lshl_b32 s37, s47, 9
  s_lshl_b32 s38, s46, 7
  s_add_u32 s38, s38, s37
  v_lshlrev_b32 v3, 1, v2
  v_lshlrev_b32 v8, 3, v2
  s_mov_b32 s40, s6
  s_and_b32 s41, s7, 0xffff
  s_mov_b32 s42, 229376
  s_mov_b32 s43, 0x20000
  buffer_load_ushort v4, v3, s[40:43], s38 offen
  s_nop 0
  s_mov_b32 s40, s8
  s_and_b32 s41, s9, 0xffff
  s_mov_b32 s42, 229376
  s_mov_b32 s43, 0x20000
  buffer_load_ushort v5, v3, s[40:43], s38 offen
  s_nop 0
  s_mov_b32 s40, s10
  s_and_b32 s41, s11, 0xffff
  s_mov_b32 s42, 229376
  s_mov_b32 s43, 0x20000
  buffer_load_ushort v6, v3, s[40:43], s38 offen
  buffer_load_dwordx2 v[18:19], v8, s[40:43], s37 offen
  s_nop 0
  s_mov_b32 s40, s12
  s_and_b32 s41, s13, 0xffff
  s_mov_b32 s42, 229376
  s_mov_b32 s43, 0x20000
  buffer_load_ushort v7, v3, s[40:43], s38 offen
  buffer_load_dwordx2 v[20:21], v8, s[40:43], s37 offen
  s_nop 0
  s_lshl_b32 s37, s44, 2
  s_load_dword s48, s[14:15], s37
  s_load_dword s49, s[16:17], s37
  s_mov_b32 s50, 0
  s_cmp_ge_u32 s2, 168
  s_cbranch_scc1 A_NOMOD
  s_cmp_lg_u32 s3, 0
  s_cbranch_scc1 A_NOMOD
  s_mov_b32 s50, 1
  s_mov_b32 s40, s72
  s_and_b32 s41, s73, 0xffff
  s_mov_b32 s42, 896
  s_mov_b32 s43, 0x20000
  buffer_load_ushort v188, v3, s[40:43], 0 offen offset:0
  buffer_load_ushort v189, v3, s[40:43], 0 offen offset:128
  buffer_load_ushort v190, v3, s[40:43], 0 offen offset:256
  buffer_load_ushort v191, v3, s[40:43], 0 offen offset:384
  buffer_load_ushort v192, v3, s[40:43], 0 offen offset:512
  buffer_load_ushort v193, v3, s[40:43], 0 offen offset:640
  buffer_load_ushort v194, v3, s[40:43], 0 offen offset:768
  s_nop 0
  s_mov_b32 s40, s74
  s_and_b32 s41, s75, 0xffff
  s_mov_b32 s42, 2408448
  s_mov_b32 s43, 0x20000
  s_and_b32 s51, s2, 7
  s_mul_i32 s51, s51, 21
  s_lshr_b32 s37, s2, 3
  s_add_u32 s51, s51, s37
  s_lshl_b32 s37, s51, 5
  v_lshrrev_b32 v9, 1, v2
  s_movk_i32 s38, 5376
  v_mul_lo_u32 v9, v9, s38
  v_and_b32 v10, 1, v2
  v_lshl_add_u32 v9, v10, 4, v9
  v_add_u32 v9, s37, v9
  s_mov_b32 m0, 131456
  s_mov_b32 s37, 0
  buffer_load_dwordx4 v9, s[40:43], s37 offen lds
  s_mov_b32 m0, 132480
  s_mov_b32 s37, 172032
  buffer_load_dwordx4 v9, s[40:43], s37 offen lds
  s_mov_b32 m0, 133504
  s_mov_b32 s37, 344064
  buffer_load_dwordx4 v9, s[40:43], s37 offen lds
  s_mov_b32 m0, 134528
  s_mov_b32 s37, 516096
  buffer_load_dwordx4 v9, s[40:43], s37 offen lds
  s_mov_b32 m0, 135552
  s_mov_b32 s37, 688128
  buffer_load_dwordx4 v9, s[40:43], s37 offen lds
  s_mov_b32 m0, 136576
  s_mov_b32 s37, 860160
  buffer_load_dwordx4 v9, s[40:43], s37 offen lds
  s_mov_b32 m0, 137600
  s_mov_b32 s37, 1032192
  buffer_load_dwordx4 v9, s[40:43], s37 offen lds
  s_mov_b32 m0, 138624
  s_mov_b32 s37, 1204224
  buffer_load_dwordx4 v9, s[40:43], s37 offen lds
  s_mov_b32 m0, 139648
  s_mov_b32 s37, 1376256
  buffer_load_dwordx4 v9, s[40:43], s37 offen lds
  s_mov_b32 m0, 140672
  s_mov_b32 s37, 1548288
  buffer_load_dwordx4 v9, s[40:43], s37 offen lds
  s_mov_b32 m0, 141696
  s_mov_b32 s37, 1720320
  buffer_load_dwordx4 v9, s[40:43], s37 offen lds
  s_mov_b32 m0, 142720
  s_mov_b32 s37, 1892352
  buffer_load_dwordx4 v9, s[40:43], s37 offen lds
  s_mov_b32 m0, 143744
  s_mov_b32 s37, 2064384
  buffer_load_dwordx4 v9, s[40:43], s37 offen lds
  s_mov_b32 m0, 144768
  s_mov_b32 s37, 2236416
  buffer_load_dwordx4 v9, s[40:43], s37 offen lds
A_NOMOD:
  s_cmp_lg_u32 s3, 1
  s_cbranch_scc1 A_NOZ
  v_lshlrev_b32 v9, 14, v2
  s_lshl_b32 s37, s2, 6
  s_add_u32 s37, s37, 147456
  s_mov_b64 exec, 31
  buffer_store_dword v24, v9, s[28:31], s37 offen sc1
  s_mov_b64 exec, -1
A_NOZ:
  v_and_b32 v29, 255, v0
  v_lshlrev_b32 v29, 3, v29
  v_sub_u32 v29, 2047, v29
  s_mul_i32 s63, s45, 9504
  s_add_u32 s63, s63, 111936
  v_mov_b32 v33, 9500
  v_subrev_u32 v30, 0, v29
  v_cvt_f32_i32 v31, v30
  v_subrev_u32 v34, 1, v29
  v_cvt_f32_i32 v32, v34
  v_cvt_pk_bf16_f32 v31, v31, v32
  v_and_b32 v32, 0xffff0000, v31
  v_lshlrev_b32 v31, 16, v31
  v_cvt_u32_f32 v31, v31
  v_lshrrev_b32 v35, 5, v31
  v_add_lshl_u32 v160, v31, v35, 2
  v_add_u32 v160, s63, v160
  v_cvt_u32_f32 v32, v32
  v_lshrrev_b32 v35, 5, v32
  v_add_lshl_u32 v161, v32, v35, 2
  v_add_u32 v161, s63, v161
  v_subrev_u32 v30, 2, v29
  v_cvt_f32_i32 v31, v30
  v_subrev_u32 v34, 3, v29
  v_cvt_f32_i32 v32, v34
  v_cvt_pk_bf16_f32 v31, v31, v32
  v_and_b32 v32, 0xffff0000, v31
  v_lshlrev_b32 v31, 16, v31
  v_cvt_u32_f32 v31, v31
  v_lshrrev_b32 v35, 5, v31
  v_add_lshl_u32 v162, v31, v35, 2
  v_add_u32 v162, s63, v162
  v_cvt_u32_f32 v32, v32
  v_lshrrev_b32 v35, 5, v32
  v_add_lshl_u32 v163, v32, v35, 2
  v_add_u32 v163, s63, v163
  v_subrev_u32 v30, 4, v29
  v_cvt_f32_i32 v31, v30
  v_subrev_u32 v34, 5, v29
  v_cvt_f32_i32 v32, v34
  v_cvt_pk_bf16_f32 v31, v31, v32
  v_and_b32 v32, 0xffff0000, v31
  v_lshlrev_b32 v31, 16, v31
  v_cvt_u32_f32 v31, v31
  v_lshrrev_b32 v35, 5, v31
  v_add_lshl_u32 v164, v31, v35, 2
  v_add_u32 v164, s63, v164
  v_cvt_u32_f32 v32, v32
  v_lshrrev_b32 v35, 5, v32
  v_add_lshl_u32 v165, v32, v35, 2
  v_add_u32 v165, s63, v165
  v_subrev_u32 v30, 6, v29
  v_cvt_f32_i32 v31, v30
  v_subrev_u32 v34, 7, v29
  v_cvt_f32_i32 v32, v34
  v_cvt_pk_bf16_f32 v31, v31, v32
  v_and_b32 v32, 0xffff0000, v31
  v_lshlrev_b32 v31, 16, v31
  v_cvt_u32_f32 v31, v31
  v_lshrrev_b32 v35, 5, v31
  v_add_lshl_u32 v166, v31, v35, 2
  v_add_u32 v166, s63, v166
  v_cvt_u32_f32 v32, v32
  v_lshrrev_b32 v35, 5, v32
  v_add_lshl_u32 v167, v32, v35, 2
  v_add_u32 v167, s63, v167
  v_subrev_u32 v30, 8, v29
  v_cvt_f32_i32 v31, v30
  v_subrev_u32 v34, 9, v29
  v_cvt_f32_i32 v32, v34
  v_cvt_pk_bf16_f32 v31, v31, v32
  v_and_b32 v32, 0xffff0000, v31
  v_lshlrev_b32 v31, 16, v31
  v_cvt_u32_f32 v31, v31
  v_lshrrev_b32 v35, 5, v31
  v_add_lshl_u32 v168, v31, v35, 2
  v_cmp_gt_i32 vcc, 0, v30
  s_nop 1
  v_cndmask_b32 v168, v168, v33, vcc
  v_add_u32 v168, s63, v168
  v_cvt_u32_f32 v32, v32
  v_lshrrev_b32 v35, 5, v32
  v_add_lshl_u32 v169, v32, v35, 2
  v_cmp_gt_i32 vcc, 0, v34
  s_nop 1
  v_cndmask_b32 v169, v169, v33, vcc
  v_add_u32 v169, s63, v169
  v_subrev_u32 v30, 10, v29
  v_cvt_f32_i32 v31, v30
  v_subrev_u32 v34, 11, v29
  v_cvt_f32_i32 v32, v34
  v_cvt_pk_bf16_f32 v31, v31, v32
  v_and_b32 v32, 0xffff0000, v31
  v_lshlrev_b32 v31, 16, v31
  v_cvt_u32_f32 v31, v31
  v_lshrrev_b32 v35, 5, v31
  v_add_lshl_u32 v170, v31, v35, 2
  v_cmp_gt_i32 vcc, 0, v30
  s_nop 1
  v_cndmask_b32 v170, v170, v33, vcc
  v_add_u32 v170, s63, v170
  v_cvt_u32_f32 v32, v32
  v_lshrrev_b32 v35, 5, v32
  v_add_lshl_u32 v171, v32, v35, 2
  v_cmp_gt_i32 vcc, 0, v34
  s_nop 1
  v_cndmask_b32 v171, v171, v33, vcc
  v_add_u32 v171, s63, v171
  v_subrev_u32 v30, 12, v29
  v_cvt_f32_i32 v31, v30
  v_subrev_u32 v34, 13, v29
  v_cvt_f32_i32 v32, v34
  v_cvt_pk_bf16_f32 v31, v31, v32
  v_and_b32 v32, 0xffff0000, v31
  v_lshlrev_b32 v31, 16, v31
  v_cvt_u32_f32 v31, v31
  v_lshrrev_b32 v35, 5, v31
  v_add_lshl_u32 v172, v31, v35, 2
  v_cmp_gt_i32 vcc, 0, v30
  s_nop 1
  v_cndmask_b32 v172, v172, v33, vcc
  v_add_u32 v172, s63, v172
  v_cvt_u32_f32 v32, v32
  v_lshrrev_b32 v35, 5, v32
  v_add_lshl_u32 v173, v32, v35, 2
  v_cmp_gt_i32 vcc, 0, v34
  s_nop 1
  v_cndmask_b32 v173, v173, v33, vcc
  v_add_u32 v173, s63, v173
  v_subrev_u32 v30, 14, v29
  v_cvt_f32_i32 v31, v30
  v_cvt_pk_bf16_f32 v31, v31, v31
  v_lshlrev_b32 v31, 16, v31
  v_cvt_u32_f32 v31, v31
  v_lshrrev_b32 v35, 5, v31
  v_add_lshl_u32 v174, v31, v35, 2
  v_cmp_gt_i32 vcc, 0, v30
  s_nop 1
  v_cndmask_b32 v174, v174, v33, vcc
  v_add_u32 v174, s63, v174
  s_mov_b32 s60, 0x3fb8aa3b
  s_mov_b32 s61, 0x32a57060
  s_mov_b32 s62, 0x3f317218
  s_mov_b32 s64, 0x3e22f983
  s_mov_b32 s65, 0x31dc9c88
  v_and_b32 v38, 15, v2
  v_lshrrev_b32 v39, 4, v2
  s_waitcnt lgkmcnt(0)
  s_lshl_b32 s37, s45, 4
  s_lshr_b32 s67, s48, s37
  s_lshl_b32 s67, s67, 16
  v_mov_b32 v40, s67
  v_mul_f32 v42, s60, v40
  v_fma_f32 v43, v40, s60, -v42
  v_fma_f32 v43, v40, s61, v43
  v_exp_f32 v41, v42
  v_mul_f32 v43, s62, v43
  v_fma_f32 v41, v41, v43, v41
  v_cvt_pk_bf16_f32 v41, v41, v41
  v_and_b32 v41, 0xffff0000, v41
  s_cmp_eq_u32 s50, 1
  s_cbranch_scc1 A_WM
  s_waitcnt vmcnt(0)
  s_branch A_W1
A_WM:
  s_waitcnt vmcnt(14)
A_W1:
  s_mov_b32 s38, 0x3f803f80
  v_mov_b32 v48, 0
  v_mov_b32 v49, 0
  v_dot2_f32_bf16 v48, v184, s38, v48
  v_dot2_f32_bf16 v48, v185, s38, v48
  v_dot2_f32_bf16 v48, v186, s38, v48
  v_dot2_f32_bf16 v48, v187, s38, v48
  v_dot2_f32_bf16 v49, v184, v184, v49
  v_dot2_f32_bf16 v49, v185, v185, v49
  v_dot2_f32_bf16 v49, v186, v186, v49
  v_dot2_f32_bf16 v49, v187, v187, v49
  v_add_f32_dpp v48, v48, v48 row_shr:1 row_mask:0xf bank_mask:0xf bound_ctrl:0
  s_nop 1
  v_add_f32_dpp v49, v49, v49 row_shr:1 row_mask:0xf bank_mask:0xf bound_ctrl:0
  v_add_f32_dpp v48, v48, v48 row_shr:2 row_mask:0xf bank_mask:0xf bound_ctrl:0
  s_nop 0
  v_add_f32_dpp v49, v49, v49 row_shr:2 row_mask:0xf bank_mask:0xf bound_ctrl:0
  v_add_f32_dpp v48, v48, v48 row_shr:4 row_mask:0xf bank_mask:0xf bound_ctrl:0
  s_nop 0
  v_add_f32_dpp v49, v49, v49 row_shr:4 row_mask:0xf bank_mask:0xf bound_ctrl:0
  v_add_f32_dpp v48, v48, v48 row_shr:8 row_mask:0xf bank_mask:0xf bound_ctrl:0
  s_nop 0
  v_add_f32_dpp v49, v49, v49 row_shr:8 row_mask:0xf bank_mask:0xf bound_ctrl:0
  v_add_f32_dpp v48, v48, v48 row_bcast:15 row_mask:0xa bank_mask:0xf
  s_nop 0
  v_add_f32_dpp v49, v49, v49 row_bcast:15 row_mask:0xa bank_mask:0xf
  v_add_f32_dpp v48, v48, v48 row_bcast:31 row_mask:0xc bank_mask:0xf
  s_nop 0
  v_add_f32_dpp v49, v49, v49 row_bcast:31 row_mask:0xc bank_mask:0xf
  v_mul_f32 v48, 0x3b124925, v48
  v_mul_f32 v49, 0x3b124925, v49
  v_fma_f32 v49, -v48, v48, v49
  v_max_f32 v49, 0, v49
  v_cvt_pk_bf16_f32 v48, v48, v48
  v_and_b32 v48, 0xffff0000, v48
  v_cvt_pk_bf16_f32 v49, v49, v49
  v_and_b32 v49, 0xffff0000, v49
  v_add_f32 v49, 0x3727c5ac, v49
  v_cvt_pk_bf16_f32 v49, v49, v49
  v_and_b32 v49, 0xffff0000, v49
  v_sqrt_f32 v49, v49
  s_nop 0
  v_cvt_pk_bf16_f32 v49, v49, v49
  v_and_b32 v49, 0xffff0000, v49
  v_rcp_f32 v49, v49
  v_readlane_b32 s38, v48, 63
  v_readlane_b32 s39, v49, 63
  s_mul_i32 s37, s3, 912
  s_add_u32 s37, s37, 111936
  v_lshl_add_u32 v50, v2, 4, s37
  v_lshlrev_b32 v52, 16, v184
  v_and_b32 v53, 0xffff0000, v184
  v_subrev_f32 v52, s38, v52
  v_subrev_f32 v53, s38, v53
  v_cvt_pk_bf16_f32 v54, v52, v53
  v_lshlrev_b32 v52, 16, v54
  v_and_b32 v53, 0xffff0000, v54
  v_mul_f32 v52, s39, v52
  v_mul_f32 v53, s39, v53
  v_cvt_pk_bf16_f32 v56, v52, v53
  v_lshlrev_b32 v52, 16, v185
  v_and_b32 v53, 0xffff0000, v185
  v_subrev_f32 v52, s38, v52
  v_subrev_f32 v53, s38, v53
  v_cvt_pk_bf16_f32 v54, v52, v53
  v_lshlrev_b32 v52, 16, v54
  v_and_b32 v53, 0xffff0000, v54
  v_mul_f32 v52, s39, v52
  v_mul_f32 v53, s39, v53
  v_cvt_pk_bf16_f32 v57, v52, v53
  v_lshlrev_b32 v52, 16, v186
  v_and_b32 v53, 0xffff0000, v186
  v_subrev_f32 v52, s38, v52
  v_subrev_f32 v53, s38, v53
  v_cvt_pk_bf16_f32 v54, v52, v53
  v_lshlrev_b32 v52, 16, v54
  v_and_b32 v53, 0xffff0000, v54
  v_mul_f32 v52, s39, v52
  v_mul_f32 v53, s39, v53
  v_cvt_pk_bf16_f32 v58, v52, v53
  v_lshlrev_b32 v52, 16, v187
  v_and_b32 v53, 0xffff0000, v187
  v_subrev_f32 v52, s38, v52
  v_subrev_f32 v53, s38, v53
  v_cvt_pk_bf16_f32 v54, v52, v53
  v_lshlrev_b32 v52, 16, v54
  v_and_b32 v53, 0xffff0000, v54
  v_mul_f32 v52, s39, v52
  v_mul_f32 v53, s39, v53
  v_cvt_pk_bf16_f32 v59, v52, v53
  v_cmp_gt_u32 vcc, 56, v2
  s_nop 0
  s_and_saveexec_b64 s[38:39], vcc
  ds_write_b128 v50, v[184:187]
  ds_write_b128 v50, v[56:59] offset:7296
  s_mov_b64 exec, -1
  v_bfe_u32 v51, v2, 2, 2
  v_mul_u32_u24 v51, 912, v51
  v_bfe_u32 v52, v2, 4, 1
  v_mul_u32_u24 v52, 7296, v52
  v_add_u32 v51, v51, v52
  v_lshrrev_b32 v52, 5, v2
  v_lshl_add_u32 v51, v52, 5, v51
  v_and_b32 v53, 3, v2
  v_lshl_add_u32 v51, v53, 3, v51
  s_lshl_b32 s37, s3, 6
  s_add_u32 s37, s37, 111936
  v_add_u32 v51, s37, v51
  v_and_b32 v53, 15, v2
  v_lshl_add_u32 v53, v52, 4, v53
  v_lshlrev_b32 v53, 5, v53
  v_bfe_u32 v52, v2, 4, 1
  v_lshl_add_u32 v53, v52, 4, v53
  s_mul_i32 s37, s2, 14336
  s_lshl_b32 s38, s3, 10
  s_add_u32 s37, s37, s38
  s_add_u32 s37, s37, 12582912
  s_add_u32 s38, s37, 8192
  s_waitcnt lgkmcnt(0)
  s_barrier
  ds_read_b64_tr_b16 v[56:57], v51
  ds_read_b64_tr_b16 v[58:59], v51 offset:3648
  ds_read_b64_tr_b16 v[60:61], v51 offset:512
  ds_read_b64_tr_b16 v[62:63], v51 offset:4160
  s_waitcnt lgkmcnt(2)
  buffer_store_dwordx4 v[56:59], v53, s[28:31], s37 offen sc1
  s_waitcnt lgkmcnt(0)
  s_cmp_ge_u32 s3, 6
  s_cbranch_scc1 LN2_1
  buffer_store_dwordx4 v[60:63], v53, s[28:31], s38 offen sc1
LN2_1:
  buffer_load_dword v195, v24, s[32:35], 0 offen sc1
  s_cmp_eq_u32 s50, 0
  s_cbranch_scc1 A_KGEN
  s_mov_b32 s37, 0xbfb8aa3b
  v_add_u32 v11, 145792, v3
  v_lshlrev_b32 v188, 16, v188
  v_mul_f32 v52, s37, v188
  v_min_f32 v52, 0x42fc0000, v52
  v_exp_f32 v52, v52
  s_nop 0
  v_add_f32 v52, 1.0, v52
  v_rcp_f32 v53, v52
  s_nop 0
  v_mul_f32 v54, v53, v188
  v_fma_f32 v55, -v54, v52, v188
  v_fma_f32 v52, v55, v53, v54
  v_cvt_pk_bf16_f32 v52, v52, v52
  ds_write_b16 v11, v52 offset:0
  v_lshlrev_b32 v189, 16, v189
  v_mul_f32 v52, s37, v189
  v_min_f32 v52, 0x42fc0000, v52
  v_exp_f32 v52, v52
  s_nop 0
  v_add_f32 v52, 1.0, v52
  v_rcp_f32 v53, v52
  s_nop 0
  v_mul_f32 v54, v53, v189
  v_fma_f32 v55, -v54, v52, v189
  v_fma_f32 v52, v55, v53, v54
  v_cvt_pk_bf16_f32 v52, v52, v52
  ds_write_b16 v11, v52 offset:128
  v_lshlrev_b32 v190, 16, v190
  v_mul_f32 v52, s37, v190
  v_min_f32 v52, 0x42fc0000, v52
  v_exp_f32 v52, v52
  s_nop 0
  v_add_f32 v52, 1.0, v52
  v_rcp_f32 v53, v52
  s_nop 0
  v_mul_f32 v54, v53, v190
  v_fma_f32 v55, -v54, v52, v190
  v_fma_f32 v52, v55, v53, v54
  v_cvt_pk_bf16_f32 v52, v52, v52
  ds_write_b16 v11, v52 offset:256
  v_lshlrev_b32 v191, 16, v191
  v_mul_f32 v52, s37, v191
  v_min_f32 v52, 0x42fc0000, v52
  v_exp_f32 v52, v52
  s_nop 0
  v_add_f32 v52, 1.0, v52
  v_rcp_f32 v53, v52
  s_nop 0
  v_mul_f32 v54, v53, v191
  v_fma_f32 v55, -v54, v52, v191
  v_fma_f32 v52, v55, v53, v54
  v_cvt_pk_bf16_f32 v52, v52, v52
  ds_write_b16 v11, v52 offset:384
  v_lshlrev_b32 v192, 16, v192
  v_mul_f32 v52, s37, v192
  v_min_f32 v52, 0x42fc0000, v52
  v_exp_f32 v52, v52
  s_nop 0
  v_add_f32 v52, 1.0, v52
  v_rcp_f32 v53, v52
  s_nop 0
  v_mul_f32 v54, v53, v192
  v_fma_f32 v55, -v54, v52, v192
  v_fma_f32 v52, v55, v53, v54
  v_cvt_pk_bf16_f32 v52, v52, v52
  ds_write_b16 v11, v52 offset:512
  v_lshlrev_b32 v193, 16, v193
  v_mul_f32 v52, s37, v193
  v_min_f32 v52, 0x42fc0000, v52
  v_exp_f32 v52, v52
  s_nop 0
  v_add_f32 v52, 1.0, v52
  v_rcp_f32 v53, v52
  s_nop 0
  v_mul_f32 v54, v53, v193
  v_fma_f32 v55, -v54, v52, v193
  v_fma_f32 v52, v55, v53, v54
  v_cvt_pk_bf16_f32 v52, v52, v52
  ds_write_b16 v11, v52 offset:640
  v_lshlrev_b32 v194, 16, v194
  v_mul_f32 v52, s37, v194
  v_min_f32 v52, 0x42fc0000, v52
  v_exp_f32 v52, v52
  s_nop 0
  v_add_f32 v52, 1.0, v52
  v_rcp_f32 v53, v52
  s_nop 0
  v_mul_f32 v54, v53, v194
  v_fma_f32 v55, -v54, v52, v194
  v_fma_f32 v52, v55, v53, v54
  v_cvt_pk_bf16_f32 v52, v52, v52
  ds_write_b16 v11, v52 offset:768
  v_add_u32 v12, 131456, v8
  v_lshlrev_b32 v13, 3, v39
  v_add_u32 v13, 145792, v13
  v_mov_b32 v52, 0
  v_mov_b32 v53, 0
  v_mov_b32 v54, 0
  v_mov_b32 v55, 0
  s_waitcnt vmcnt(3) lgkmcnt(0)
  ds_read_b64_tr_b16 v[56:57], v12 offset:0
  ds_read_b64_tr_b16 v[58:59], v12 offset:512
  ds_read2_b64 v[60:63], v13 offset0:0 offset1:4
  ds_read_b64_tr_b16 v[64:65], v12 offset:1024
  ds_read_b64_tr_b16 v[66:67], v12 offset:1536
  ds_read2_b64 v[68:71], v13 offset0:8 offset1:12
  ds_read_b64_tr_b16 v[72:73], v12 offset:2048
  ds_read_b64_tr_b16 v[74:75], v12 offset:2560
  ds_read2_b64 v[76:79], v13 offset0:16 offset1:20
  ds_read_b64_tr_b16 v[80:81], v12 offset:3072
  ds_read_b64_tr_b16 v[82:83], v12 offset:3584
  ds_read2_b64 v[84:87], v13 offset0:24 offset1:28
  ds_read_b64_tr_b16 v[88:89], v12 offset:4096
  ds_read_b64_tr_b16 v[90:91], v12 offset:4608
  ds_read2_b64 v[92:95], v13 offset0:32 offset1:36
  s_waitcnt lgkmcnt(12)
  v_mfma_f32_16x16x32_bf16 v[52:55], v[56:59], v[60:63], v[52:55]
  ds_read_b64_tr_b16 v[96:97], v12 offset:5120
  ds_read_b64_tr_b16 v[98:99], v12 offset:5632
  ds_read2_b64 v[100:103], v13 offset0:40 offset1:44
  s_waitcnt lgkmcnt(12)
  v_mfma_f32_16x16x32_bf16 v[52:55], v[64:67], v[68:71], v[52:55]
  ds_read_b64_tr_b16 v[104:105], v12 offset:6144
  ds_read_b64_tr_b16 v[106:107], v12 offset:6656
  ds_read2_b64 v[108:111], v13 offset0:48 offset1:52
  s_waitcnt lgkmcnt(12)
  v_mfma_f32_16x16x32_bf16 v[52:55], v[72:75], v[76:79], v[52:55]
  ds_read_b64_tr_b16 v[56:57], v12 offset:7168
  ds_read_b64_tr_b16 v[58:59], v12 offset:7680
  ds_read2_b64 v[60:63], v13 offset0:56 offset1:60
  s_waitcnt lgkmcnt(12)
  v_mfma_f32_16x16x32_bf16 v[52:55], v[80:83], v[84:87], v[52:55]
  ds_read_b64_tr_b16 v[64:65], v12 offset:8192
  ds_read_b64_tr_b16 v[66:67], v12 offset:8704
  ds_read2_b64 v[68:71], v13 offset0:64 offset1:68
  s_waitcnt lgkmcnt(12)
  v_mfma_f32_16x16x32_bf16 v[52:55], v[88:91], v[92:95], v[52:55]
  ds_read_b64_tr_b16 v[72:73], v12 offset:9216
  ds_read_b64_tr_b16 v[74:75], v12 offset:9728
  ds_read2_b64 v[76:79], v13 offset0:72 offset1:76
  s_waitcnt lgkmcnt(12)
  v_mfma_f32_16x16x32_bf16 v[52:55], v[96:99], v[100:103], v[52:55]
  ds_read_b64_tr_b16 v[80:81], v12 offset:10240
  ds_read_b64_tr_b16 v[82:83], v12 offset:10752
  ds_read2_b64 v[84:87], v13 offset0:80 offset1:84
  s_waitcnt lgkmcnt(12)
  v_mfma_f32_16x16x32_bf16 v[52:55], v[104:107], v[108:111], v[52:55]
  ds_read_b64_tr_b16 v[88:89], v12 offset:11264
  ds_read_b64_tr_b16 v[90:91], v12 offset:11776
  ds_read2_b64 v[92:95], v13 offset0:88 offset1:92
  s_waitcnt lgkmcnt(12)
  v_mfma_f32_16x16x32_bf16 v[52:55], v[56:59], v[60:63], v[52:55]
  ds_read_b64_tr_b16 v[96:97], v12 offset:12288
  ds_read_b64_tr_b16 v[98:99], v12 offset:12800
  ds_read2_b64 v[100:103], v13 offset0:96 offset1:100
  s_waitcnt lgkmcnt(12)
  v_mfma_f32_16x16x32_bf16 v[52:55], v[64:67], v[68:71], v[52:55]
  ds_read_b64_tr_b16 v[104:105], v12 offset:13312
  ds_read_b64_tr_b16 v[106:107], v12 offset:13824
  ds_read2_b64 v[108:111], v13 offset0:104 offset1:108
  s_waitcnt lgkmcnt(12)
  v_mfma_f32_16x16x32_bf16 v[52:55], v[72:75], v[76:79], v[52:55]
  s_waitcnt lgkmcnt(9)
  v_mfma_f32_16x16x32_bf16 v[52:55], v[80:83], v[84:87], v[52:55]
  s_waitcnt lgkmcnt(6)
  v_mfma_f32_16x16x32_bf16 v[52:55], v[88:91], v[92:95], v[52:55]
  s_waitcnt lgkmcnt(3)
  v_mfma_f32_16x16x32_bf16 v[52:55], v[96:99], v[100:103], v[52:55]
  s_waitcnt lgkmcnt(0)
  v_mfma_f32_16x16x32_bf16 v[52:55], v[104:107], v[108:111], v[52:55]
  s_nop 7
  v_cvt_pk_bf16_f32 v52, v52, v52
  v_and_b32 v52, 0xffff0000, v52
  v_cvt_pk_bf16_f32 v53, v53, v53
  v_and_b32 v53, 0xffff0000, v53
  v_cvt_pk_bf16_f32 v54, v54, v54
  v_and_b32 v54, 0xffff0000, v54
  v_cvt_pk_bf16_f32 v55, v55, v55
  v_and_b32 v55, 0xffff0000, v55
  v_lshlrev_b32 v13, 4, v39
  s_lshl_b32 s37, s51, 6
  s_add_u32 s37, s37, 16384
  v_cmp_eq_u32 vcc, 0, v38
  s_nop 0
  s_and_saveexec_b64 s[38:39], vcc
  buffer_store_dwordx4 v[52:55], v13, s[28:31], s37 offen sc1
  v_cvt_pk_bf16_f32 v60, v52, v53
  v_cvt_pk_bf16_f32 v61, v54, v55
  v_add_f32 v56, 1.0, v52
  v_add_f32 v57, 1.0, v53
  v_add_f32 v58, 1.0, v54
  v_add_f32 v59, 1.0, v55
  v_cvt_pk_bf16_f32 v57, v56, v57
  v_cvt_pk_bf16_f32 v59, v58, v59
  v_lshlrev_b32 v56, 16, v57
  v_and_b32 v57, 0xffff0000, v57
  v_lshlrev_b32 v58, 16, v59
  v_and_b32 v59, 0xffff0000, v59
  s_add_u32 s37, s37, 49152
  buffer_store_dwordx4 v[56:59], v13, s[28:31], s37 offen sc1
  v_lshlrev_b32 v13, 3, v39
  s_lshl_b32 s37, s51, 5
  s_add_u32 s37, s37, 81920
  buffer_store_dwordx2 v[60:61], v13, s[28:31], s37 offen sc1
  s_mov_b64 exec, -1
A_KGEN:
  s_mul_i32 s66, s45, 55968
  s_lshl_b32 s37, s46, 8
  s_add_u32 s37, s37, s66
  v_lshl_add_u32 v36, v2, 2, s37
  v_and_b32 v38, 15, v2
  s_movk_i32 s37, 1056
  v_mul_lo_u32 v37, v38, s37
  v_lshrrev_b32 v39, 4, v2
  v_lshl_add_u32 v37, v39, 4, v37
  s_lshr_b32 s52, s46, 1
  s_and_b32 s53, s46, 1
  s_mul_i32 s37, s52, 16896
  s_add_u32 s37, s37, s66
  s_mul_i32 s38, s53, 16896
  s_add_u32 s38, s38, s66
  s_add_u32 s38, s38, 22176
  v_add_u32 v178, s38, v37
  v_add_u32 v37, s37, v37
  s_lshl_b32 s37, s53, 4
  v_add_u32 v30, s37, v38
  v_lshrrev_b32 v31, 2, v30
  v_lshl_add_u32 v31, v30, 3, v31
  v_lshl_add_u32 v31, v31, 2, s63
  v_cmp_eq_u32 s[38:39], 1, v39
  v_cmp_eq_u32 s[54:55], 2, v39
  v_cmp_eq_u32 vcc, 3, v39
  s_cmp_eq_u32 s52, 0
  s_movk_i32 s37, 0
  s_cselect_b32 s37, s37, 4224
  v_mov_b32 v180, s37
  s_movk_i32 s37, 16
  s_cselect_b32 s37, s37, 8448
  v_mov_b32 v32, s37
  v_cndmask_b32 v180, v180, v32, s[38:39]
  s_movk_i32 s37, 1056
  s_cselect_b32 s37, s37, 8464
  v_mov_b32 v32, s37
  v_cndmask_b32 v180, v180, v32, s[54:55]
  s_movk_i32 s37, 2112
  s_cselect_b32 s37, s37, 8464
  v_mov_b32 v32, s37
  v_cndmask_b32 v180, v180, v32, vcc
  v_add_u32 v180, v180, v31
  s_movk_i32 s37, 4
  s_cselect_b32 s37, s37, 5280
  v_mov_b32 v181, s37
  s_movk_i32 s37, 20
  s_cselect_b32 s37, s37, 8464
  v_mov_b32 v32, s37
  v_cndmask_b32 v181, v181, v32, s[38:39]
  s_movk_i32 s37, 1064
  s_cselect_b32 s37, s37, 8464
  v_mov_b32 v32, s37
  v_cndmask_b32 v181, v181, v32, s[54:55]
  s_movk_i32 s37, 2128
  s_cselect_b32 s37, s37, 8464
  v_mov_b32 v32, s37
  v_cndmask_b32 v181, v181, v32, vcc
  v_add_u32 v181, v181, v31
  s_movk_i32 s37, 8
  s_cselect_b32 s37, s37, 6336
  v_mov_b32 v182, s37
  s_movk_i32 s37, 24
  s_cselect_b32 s37, s37, 8464
  v_mov_b32 v32, s37
  v_cndmask_b32 v182, v182, v32, s[38:39]
  s_movk_i32 s37, 1072
  s_cselect_b32 s37, s37, 8464
  v_mov_b32 v32, s37
  v_cndmask_b32 v182, v182, v32, s[54:55]
  s_movk_i32 s37, 3168
  s_cselect_b32 s37, s37, 8464
  v_mov_b32 v32, s37
  v_cndmask_b32 v182, v182, v32, vcc
  v_add_u32 v182, v182, v31
  s_movk_i32 s37, 12
  s_cselect_b32 s37, s37, 7392
  v_mov_b32 v183, s37
  s_movk_i32 s37, 28
  s_cselect_b32 s37, s37, 8464
  v_mov_b32 v32, s37
  v_cndmask_b32 v183, v183, v32, s[38:39]
  s_movk_i32 s37, 1080
  s_cselect_b32 s37, s37, 8464
  v_mov_b32 v32, s37
  v_cndmask_b32 v183, v183, v32, s[54:55]
  s_movk_i32 s37, 3184
  s_cselect_b32 s37, s37, 8464
  v_mov_b32 v32, s37
  v_cndmask_b32 v183, v183, v32, vcc
  v_add_u32 v183, v183, v31
  v_lshlrev_b32 v4, 16, v4
  v_lshlrev_b32 v5, 16, v5
  v_lshlrev_b32 v6, 16, v6
  v_lshlrev_b32 v7, 16, v7
  v_mul_f32 v42, s60, v4
  v_fma_f32 v43, v4, s60, -v42
  v_fma_f32 v43, v4, s61, v43
  v_exp_f32 v44, v42
  v_mul_f32 v43, s62, v43
  v_fma_f32 v44, v44, v43, v44
  v_cvt_pk_bf16_f32 v44, v44, v44
  v_and_b32 v44, 0xffff0000, v44
  v_mul_f32 v44, v44, v41
  v_mul_f32 v44, s60, v44
  v_mul_f32 v45, v5, v41
  v_mul_f32 v46, s64, v45
  v_fma_f32 v47, v45, s64, -v46
  v_fma_f32 v47, v45, s65, v47
  v_and_b32 v18, 0x7fff7fff, v18
  v_and_b32 v19, 0x7fff7fff, v19
  v_and_b32 v20, 0x7fff7fff, v20
  v_and_b32 v21, 0x7fff7fff, v21
  v_pk_max_u16 v18, v18, v19
  v_pk_max_u16 v20, v20, v21
  v_pk_max_u16 v18, v18, v20
  v_lshrrev_b32 v19, 16, v18
  v_and_b32 v18, 0xffff, v18
  v_max_u32 v48, v18, v19
  s_nop 1
  v_max_u32_dpp v48, v48, v48 row_shr:1 row_mask:0xf bank_mask:0xf bound_ctrl:0
  s_nop 1
  v_max_u32_dpp v48, v48, v48 row_shr:2 row_mask:0xf bank_mask:0xf bound_ctrl:0
  s_nop 1
  v_max_u32_dpp v48, v48, v48 row_shr:4 row_mask:0xf bank_mask:0xf bound_ctrl:0
  s_nop 1
  v_max_u32_dpp v48, v48, v48 row_shr:8 row_mask:0xf bank_mask:0xf bound_ctrl:0
  s_nop 1
  v_max_u32_dpp v48, v48, v48 row_bcast:15 row_mask:0xa bank_mask:0xf
  s_nop 1
  v_max_u32_dpp v48, v48, v48 row_bcast:31 row_mask:0xc bank_mask:0xf
  s_nop 0
  v_readlane_b32 s56, v48, 63
  s_nop 0
  s_lshr_b32 s56, s56, 7
  s_sub_i32 s56, s56, 126
  s_sub_i32 s57, 6, s56
  v_mul_f32 v42, 0xbf800000, v44
  v_exp_f32 v42, v42
  v_mul_f32 v43, 0x3f800000, v46
  v_fract_f32 v43, v43
  v_mul_f32 v49, 0x3f800000, v47
  v_add_f32 v43, v43, v49
  v_cos_f32 v50, v43
  v_sin_f32 v51, v43
  v_mul_f32 v50, v50, v42
  v_mul_f32 v51, v51, v42
  v_mul_f32 v42, 0xc1000000, v44
  v_exp_f32 v42, v42
  v_mul_f32 v43, 0x41000000, v46
  v_fract_f32 v43, v43
  v_mul_f32 v49, 0x41000000, v47
  v_add_f32 v43, v43, v49
  v_cos_f32 v52, v43
  v_sin_f32 v53, v43
  v_mul_f32 v52, v52, v42
  v_mul_f32 v53, v53, v42
  v_mul_f32 v42, 0xc3800000, v44
  v_exp_f32 v42, v42
  v_mul_f32 v43, 0x43800000, v46
  v_fract_f32 v43, v43
  v_mul_f32 v49, 0x43800000, v47
  v_add_f32 v43, v43, v49
  v_cos_f32 v54, v43
  v_sin_f32 v55, v43
  v_mul_f32 v54, v54, v42
  v_mul_f32 v55, v55, v42
  s_waitcnt vmcnt(0)
  s_mov_b64 exec, 1
  v_mov_b32 v100, 159744
  v_mov_b32 v101, 1
  ds_add_rtn_u32 v102, v100, v101
  s_waitcnt lgkmcnt(0)
  v_readfirstlane_b32 s37, v102
  s_nop 0
  s_cmp_lg_u32 s37, 7
  s_cbranch_scc1 ARR_2
  s_mov_b32 s38, 0
  v_mov_b32 v100, 0
  v_readfirstlane_b32 s37, v195
  s_nop 0
  s_cmp_lg_u32 s37, 0
  s_cbranch_scc1 GO_3D
GO_3:
  buffer_load_dword v102, v100, s[32:35], 0 offen sc1
  s_waitcnt vmcnt(0)
  v_readfirstlane_b32 s37, v102
  s_add_u32 s38, s38, 1
  s_cmp_ge_u32 s38, 60000
  s_cbranch_scc1 GO_3D
  s_cmp_eq_u32 s37, 0
  s_cbranch_scc1 GO_3
GO_3D:
  s_lshl_b32 s37, s2, 6
  s_add_u32 s37, s37, 131072
  v_mov_b32 v100, 0
  v_mov_b32 v101, 1
  buffer_store_dword v101, v100, s[28:31], s37 offen sc1
ARR_2:
  s_mov_b64 exec, -1
  v_pk_mul_f32 v[44:45], v[50:51], v[50:51] op_sel:[0,0] op_sel_hi:[1,0]
  v_pk_fma_f32 v[56:57], v[50:51], v[50:51], v[44:45] op_sel:[1,1,0] op_sel_hi:[0,1,1] neg_lo:[1,0,0]
  v_pk_mul_f32 v[42:43], v[54:55], v[54:55] op_sel:[0,0] op_sel_hi:[1,0]
  v_pk_fma_f32 v[58:59], v[54:55], v[54:55], v[42:43] op_sel:[1,1,0] op_sel_hi:[0,1,1] neg_lo:[1,0,0]
  v_pk_mul_f32 v[44:45], v[56:57], v[50:51] op_sel:[0,0] op_sel_hi:[1,0]
  v_pk_fma_f32 v[60:61], v[56:57], v[50:51], v[44:45] op_sel:[1,1,0] op_sel_hi:[0,1,1] neg_lo:[1,0,0]
  v_pk_mul_f32 v[42:43], v[56:57], v[56:57] op_sel:[0,0] op_sel_hi:[1,0]
  v_pk_fma_f32 v[62:63], v[56:57], v[56:57], v[42:43] op_sel:[1,1,0] op_sel_hi:[0,1,1] neg_lo:[1,0,0]
  v_pk_mul_f32 v[44:45], v[58:59], v[54:55] op_sel:[0,0] op_sel_hi:[1,0]
  v_pk_fma_f32 v[64:65], v[58:59], v[54:55], v[44:45] op_sel:[1,1,0] op_sel_hi:[0,1,1] neg_lo:[1,0,0]
  v_pk_mul_f32 v[42:43], v[58:59], v[58:59] op_sel:[0,0] op_sel_hi:[1,0]
  v_pk_fma_f32 v[66:67], v[58:59], v[58:59], v[42:43] op_sel:[1,1,0] op_sel_hi:[0,1,1] neg_lo:[1,0,0]
  v_pk_mul_f32 v[44:45], v[62:63], v[50:51] op_sel:[0,0] op_sel_hi:[1,0]
  v_pk_fma_f32 v[68:69], v[62:63], v[50:51], v[44:45] op_sel:[1,1,0] op_sel_hi:[0,1,1] neg_lo:[1,0,0]
  v_pk_mul_f32 v[42:43], v[62:63], v[56:57] op_sel:[0,0] op_sel_hi:[1,0]
  v_pk_fma_f32 v[70:71], v[62:63], v[56:57], v[42:43] op_sel:[1,1,0] op_sel_hi:[0,1,1] neg_lo:[1,0,0]
  v_pk_mul_f32 v[44:45], v[62:63], v[60:61] op_sel:[0,0] op_sel_hi:[1,0]
  v_pk_fma_f32 v[72:73], v[62:63], v[60:61], v[44:45] op_sel:[1,1,0] op_sel_hi:[0,1,1] neg_lo:[1,0,0]
  v_pk_mul_f32 v[42:43], v[66:67], v[54:55] op_sel:[0,0] op_sel_hi:[1,0]
  v_pk_fma_f32 v[74:75], v[66:67], v[54:55], v[42:43] op_sel:[1,1,0] op_sel_hi:[0,1,1] neg_lo:[1,0,0]
  v_pk_mul_f32 v[44:45], v[66:67], v[58:59] op_sel:[0,0] op_sel_hi:[1,0]
  v_pk_fma_f32 v[76:77], v[66:67], v[58:59], v[44:45] op_sel:[1,1,0] op_sel_hi:[0,1,1] neg_lo:[1,0,0]
  v_pk_mul_f32 v[42:43], v[66:67], v[64:65] op_sel:[0,0] op_sel_hi:[1,0]
  v_pk_fma_f32 v[78:79], v[66:67], v[64:65], v[42:43] op_sel:[1,1,0] op_sel_hi:[0,1,1] neg_lo:[1,0,0]
  v_pk_mul_f32 v[44:45], v[66:67], v[66:67] op_sel:[0,0] op_sel_hi:[1,0]
  v_pk_fma_f32 v[80:81], v[66:67], v[66:67], v[44:45] op_sel:[1,1,0] op_sel_hi:[0,1,1] neg_lo:[1,0,0]
  v_pk_mul_f32 v[42:43], v[54:55], v[56:57] op_sel:[0,0] op_sel_hi:[1,0]
  v_pk_fma_f32 v[82:83], v[54:55], v[56:57], v[42:43] op_sel:[1,1,0] op_sel_hi:[0,1,1] neg_lo:[1,0,0]
  v_pk_mul_f32 v[44:45], v[54:55], v[62:63] op_sel:[0,0] op_sel_hi:[1,0]
  v_pk_fma_f32 v[84:85], v[54:55], v[62:63], v[44:45] op_sel:[1,1,0] op_sel_hi:[0,1,1] neg_lo:[1,0,0]
  v_pk_mul_f32 v[42:43], v[54:55], v[70:71] op_sel:[0,0] op_sel_hi:[1,0]
  v_pk_fma_f32 v[86:87], v[54:55], v[70:71], v[42:43] op_sel:[1,1,0] op_sel_hi:[0,1,1] neg_lo:[1,0,0]
  v_pk_mul_f32 v[44:45], v[58:59], v[62:63] op_sel:[0,0] op_sel_hi:[1,0]
  v_pk_fma_f32 v[88:89], v[58:59], v[62:63], v[44:45] op_sel:[1,1,0] op_sel_hi:[0,1,1] neg_lo:[1,0,0]
  v_pk_mul_f32 v[42:43], v[64:65], v[62:63] op_sel:[0,0] op_sel_hi:[1,0]
  v_pk_fma_f32 v[90:91], v[64:65], v[62:63], v[42:43] op_sel:[1,1,0] op_sel_hi:[0,1,1] neg_lo:[1,0,0]
  v_pk_mul_f32 v[44:45], v[52:53], v[52:53] op_sel:[0,0] op_sel_hi:[1,0]
  v_pk_fma_f32 v[92:93], v[52:53], v[52:53], v[44:45] op_sel:[1,1,0] op_sel_hi:[0,1,1] neg_lo:[1,0,0]
  v_mov_b32 v42, 0x00003c00
  ds_write_b32 v36, v42
  v_cvt_pk_f16_f32 v43, v50, v51
  ds_write_b32 v36, v43 offset:1056
  v_cvt_pk_f16_f32 v42, v56, v57
  ds_write_b32 v36, v42 offset:2112
  v_cvt_pk_f16_f32 v43, v60, v61
  ds_write_b32 v36, v43 offset:3168
  v_cvt_pk_f16_f32 v42, v62, v63
  ds_write_b32 v36, v42 offset:4224
  v_cvt_pk_f16_f32 v43, v68, v69
  ds_write_b32 v36, v43 offset:5280
  v_cvt_pk_f16_f32 v42, v70, v71
  ds_write_b32 v36, v42 offset:6336
  v_cvt_pk_f16_f32 v43, v72, v73
  ds_write_b32 v36, v43 offset:7392
  v_cvt_pk_f16_f32 v42, v54, v55
  ds_write_b32 v36, v42 offset:8448
  v_cvt_pk_f16_f32 v43, v82, v83
  ds_write_b32 v36, v43 offset:9504
  v_cvt_pk_f16_f32 v42, v84, v85
  ds_write_b32 v36, v42 offset:10560
  v_cvt_pk_f16_f32 v43, v86, v87
  ds_write_b32 v36, v43 offset:11616
  v_cvt_pk_f16_f32 v42, v58, v59
  ds_write_b32 v36, v42 offset:12672
  v_cvt_pk_f16_f32 v43, v88, v89
  ds_write_b32 v36, v43 offset:13728
  v_cvt_pk_f16_f32 v42, v64, v65
  ds_write_b32 v36, v42 offset:14784
  v_cvt_pk_f16_f32 v43, v90, v91
  ds_write_b32 v36, v43 offset:15840
  v_cvt_pk_f16_f32 v42, v66, v67
  ds_write_b32 v36, v42 offset:16896
  v_cvt_pk_f16_f32 v43, v74, v75
  ds_write_b32 v36, v43 offset:17952
  v_cvt_pk_f16_f32 v42, v76, v77
  ds_write_b32 v36, v42 offset:19008
  v_cvt_pk_f16_f32 v43, v78, v79
  ds_write_b32 v36, v43 offset:20064
  v_cvt_pk_f16_f32 v42, v80, v81
  ds_write_b32 v36, v42 offset:21120
  v_ldexp_f32 v96, v6, s57
  v_ldexp_f32 v97, v7, s57
  v_pk_mul_f32 v[42:43], v[96:97], v[52:53] op_sel:[0,0] op_sel_hi:[1,0]
  v_pk_fma_f32 v[98:99], v[96:97], v[52:53], v[42:43] op_sel:[1,1,0] op_sel_hi:[0,1,1] neg_lo:[1,0,0]
  v_cvt_pk_f16_f32 v46, v96, -v97
  ds_write_b32 v36, v46 offset:22176
  v_pk_mul_f32 v[42:43], v[96:97], v[92:93] op_sel:[0,0] op_sel_hi:[1,0]
  v_pk_fma_f32 v[96:97], v[96:97], v[92:93], v[42:43] op_sel:[1,1,0] op_sel_hi:[0,1,1] neg_lo:[1,0,0]
  v_cvt_pk_f16_f32 v47, v98, -v99
  ds_write_b32 v36, v47 offset:23232
  v_pk_mul_f32 v[44:45], v[98:99], v[92:93] op_sel:[0,0] op_sel_hi:[1,0]
  v_pk_fma_f32 v[98:99], v[98:99], v[92:93], v[44:45] op_sel:[1,1,0] op_sel_hi:[0,1,1] neg_lo:[1,0,0]
  v_cvt_pk_f16_f32 v46, v96, -v97
  ds_write_b32 v36, v46 offset:24288
  v_pk_mul_f32 v[42:43], v[96:97], v[92:93] op_sel:[0,0] op_sel_hi:[1,0]
  v_pk_fma_f32 v[96:97], v[96:97], v[92:93], v[42:43] op_sel:[1,1,0] op_sel_hi:[0,1,1] neg_lo:[1,0,0]
  v_cvt_pk_f16_f32 v47, v98, -v99
  ds_write_b32 v36, v47 offset:25344
  v_pk_mul_f32 v[44:45], v[98:99], v[92:93] op_sel:[0,0] op_sel_hi:[1,0]
  v_pk_fma_f32 v[98:99], v[98:99], v[92:93], v[44:45] op_sel:[1,1,0] op_sel_hi:[0,1,1] neg_lo:[1,0,0]
  v_cvt_pk_f16_f32 v46, v96, -v97
  ds_write_b32 v36, v46 offset:26400
  v_pk_mul_f32 v[42:43], v[96:97], v[92:93] op_sel:[0,0] op_sel_hi:[1,0]
  v_pk_fma_f32 v[96:97], v[96:97], v[92:93], v[42:43] op_sel:[1,1,0] op_sel_hi:[0,1,1] neg_lo:[1,0,0]
  v_cvt_pk_f16_f32 v47, v98, -v99
  ds_write_b32 v36, v47 offset:27456
  v_pk_mul_f32 v[44:45], v[98:99], v[92:93] op_sel:[0,0] op_sel_hi:[1,0]
  v_pk_fma_f32 v[98:99], v[98:99], v[92:93], v[44:45] op_sel:[1,1,0] op_sel_hi:[0,1,1] neg_lo:[1,0,0]
  v_cvt_pk_f16_f32 v46, v96, -v97
  ds_write_b32 v36, v46 offset:28512
  v_pk_mul_f32 v[42:43], v[96:97], v[92:93] op_sel:[0,0] op_sel_hi:[1,0]
  v_pk_fma_f32 v[96:97], v[96:97], v[92:93], v[42:43] op_sel:[1,1,0] op_sel_hi:[0,1,1] neg_lo:[1,0,0]
  v_cvt_pk_f16_f32 v47, v98, -v99
  ds_write_b32 v36, v47 offset:29568
  v_pk_mul_f32 v[44:45], v[98:99], v[92:93] op_sel:[0,0] op_sel_hi:[1,0]
  v_pk_fma_f32 v[98:99], v[98:99], v[92:93], v[44:45] op_sel:[1,1,0] op_sel_hi:[0,1,1] neg_lo:[1,0,0]
  v_cvt_pk_f16_f32 v46, v96, -v97
  ds_write_b32 v36, v46 offset:30624
  v_pk_mul_f32 v[42:43], v[96:97], v[92:93] op_sel:[0,0] op_sel_hi:[1,0]
  v_pk_fma_f32 v[96:97], v[96:97], v[92:93], v[42:43] op_sel:[1,1,0] op_sel_hi:[0,1,1] neg_lo:[1,0,0]
  v_cvt_pk_f16_f32 v47, v98, -v99
  ds_write_b32 v36, v47 offset:31680
  v_pk_mul_f32 v[44:45], v[98:99], v[92:93] op_sel:[0,0] op_sel_hi:[1,0]
  v_pk_fma_f32 v[98:99], v[98:99], v[92:93], v[44:45] op_sel:[1,1,0] op_sel_hi:[0,1,1] neg_lo:[1,0,0]
  v_cvt_pk_f16_f32 v46, v96, -v97
  ds_write_b32 v36, v46 offset:32736
  v_pk_mul_f32 v[42:43], v[96:97], v[92:93] op_sel:[0,0] op_sel_hi:[1,0]
  v_pk_fma_f32 v[96:97], v[96:97], v[92:93], v[42:43] op_sel:[1,1,0] op_sel_hi:[0,1,1] neg_lo:[1,0,0]
  v_cvt_pk_f16_f32 v47, v98, -v99
  ds_write_b32 v36, v47 offset:33792
  v_pk_mul_f32 v[44:45], v[98:99], v[92:93] op_sel:[0,0] op_sel_hi:[1,0]
  v_pk_fma_f32 v[98:99], v[98:99], v[92:93], v[44:45] op_sel:[1,1,0] op_sel_hi:[0,1,1] neg_lo:[1,0,0]
  v_cvt_pk_f16_f32 v46, v96, -v97
  ds_write_b32 v36, v46 offset:34848
  v_pk_mul_f32 v[42:43], v[96:97], v[92:93] op_sel:[0,0] op_sel_hi:[1,0]
  v_pk_fma_f32 v[96:97], v[96:97], v[92:93], v[42:43] op_sel:[1,1,0] op_sel_hi:[0,1,1] neg_lo:[1,0,0]
  v_cvt_pk_f16_f32 v47, v98, -v99
  ds_write_b32 v36, v47 offset:35904
  v_pk_mul_f32 v[44:45], v[98:99], v[92:93] op_sel:[0,0] op_sel_hi:[1,0]
  v_pk_fma_f32 v[98:99], v[98:99], v[92:93], v[44:45] op_sel:[1,1,0] op_sel_hi:[0,1,1] neg_lo:[1,0,0]
  v_cvt_pk_f16_f32 v46, v96, -v97
  ds_write_b32 v36, v46 offset:36960
  v_pk_mul_f32 v[42:43], v[96:97], v[92:93] op_sel:[0,0] op_sel_hi:[1,0]
  v_pk_fma_f32 v[96:97], v[96:97], v[92:93], v[42:43] op_sel:[1,1,0] op_sel_hi:[0,1,1] neg_lo:[1,0,0]
  v_cvt_pk_f16_f32 v47, v98, -v99
  ds_write_b32 v36, v47 offset:38016
  v_pk_mul_f32 v[44:45], v[98:99], v[92:93] op_sel:[0,0] op_sel_hi:[1,0]
  v_pk_fma_f32 v[98:99], v[98:99], v[92:93], v[44:45] op_sel:[1,1,0] op_sel_hi:[0,1,1] neg_lo:[1,0,0]
  v_cvt_pk_f16_f32 v46, v96, -v97
  ds_write_b32 v36, v46 offset:39072
  v_pk_mul_f32 v[42:43], v[96:97], v[92:93] op_sel:[0,0] op_sel_hi:[1,0]
  v_pk_fma_f32 v[96:97], v[96:97], v[92:93], v[42:43] op_sel:[1,1,0] op_sel_hi:[0,1,1] neg_lo:[1,0,0]
  v_cvt_pk_f16_f32 v47, v98, -v99
  ds_write_b32 v36, v47 offset:40128
  v_pk_mul_f32 v[44:45], v[98:99], v[92:93] op_sel:[0,0] op_sel_hi:[1,0]
  v_pk_fma_f32 v[98:99], v[98:99], v[92:93], v[44:45] op_sel:[1,1,0] op_sel_hi:[0,1,1] neg_lo:[1,0,0]
  v_cvt_pk_f16_f32 v46, v96, -v97
  ds_write_b32 v36, v46 offset:41184
  v_pk_mul_f32 v[42:43], v[96:97], v[92:93] op_sel:[0,0] op_sel_hi:[1,0]
  v_pk_fma_f32 v[96:97], v[96:97], v[92:93], v[42:43] op_sel:[1,1,0] op_sel_hi:[0,1,1] neg_lo:[1,0,0]
  v_cvt_pk_f16_f32 v47, v98, -v99
  ds_write_b32 v36, v47 offset:42240
  v_pk_mul_f32 v[44:45], v[98:99], v[92:93] op_sel:[0,0] op_sel_hi:[1,0]
  v_pk_fma_f32 v[98:99], v[98:99], v[92:93], v[44:45] op_sel:[1,1,0] op_sel_hi:[0,1,1] neg_lo:[1,0,0]
  v_cvt_pk_f16_f32 v46, v96, -v97
  ds_write_b32 v36, v46 offset:43296
  v_pk_mul_f32 v[42:43], v[96:97], v[92:93] op_sel:[0,0] op_sel_hi:[1,0]
  v_pk_fma_f32 v[96:97], v[96:97], v[92:93], v[42:43] op_sel:[1,1,0] op_sel_hi:[0,1,1] neg_lo:[1,0,0]
  v_cvt_pk_f16_f32 v47, v98, -v99
  ds_write_b32 v36, v47 offset:44352
  v_pk_mul_f32 v[44:45], v[98:99], v[92:93] op_sel:[0,0] op_sel_hi:[1,0]
  v_pk_fma_f32 v[98:99], v[98:99], v[92:93], v[44:45] op_sel:[1,1,0] op_sel_hi:[0,1,1] neg_lo:[1,0,0]
  v_cvt_pk_f16_f32 v46, v96, -v97
  ds_write_b32 v36, v46 offset:45408
  v_pk_mul_f32 v[42:43], v[96:97], v[92:93] op_sel:[0,0] op_sel_hi:[1,0]
  v_pk_fma_f32 v[96:97], v[96:97], v[92:93], v[42:43] op_sel:[1,1,0] op_sel_hi:[0,1,1] neg_lo:[1,0,0]
  v_cvt_pk_f16_f32 v47, v98, -v99
  ds_write_b32 v36, v47 offset:46464
  v_pk_mul_f32 v[44:45], v[98:99], v[92:93] op_sel:[0,0] op_sel_hi:[1,0]
  v_pk_fma_f32 v[98:99], v[98:99], v[92:93], v[44:45] op_sel:[1,1,0] op_sel_hi:[0,1,1] neg_lo:[1,0,0]
  v_cvt_pk_f16_f32 v46, v96, -v97
  ds_write_b32 v36, v46 offset:47520
  v_pk_mul_f32 v[42:43], v[96:97], v[92:93] op_sel:[0,0] op_sel_hi:[1,0]
  v_pk_fma_f32 v[96:97], v[96:97], v[92:93], v[42:43] op_sel:[1,1,0] op_sel_hi:[0,1,1] neg_lo:[1,0,0]
  v_cvt_pk_f16_f32 v47, v98, -v99
  ds_write_b32 v36, v47 offset:48576
  v_pk_mul_f32 v[44:45], v[98:99], v[92:93] op_sel:[0,0] op_sel_hi:[1,0]
  v_pk_fma_f32 v[98:99], v[98:99], v[92:93], v[44:45] op_sel:[1,1,0] op_sel_hi:[0,1,1] neg_lo:[1,0,0]
  v_cvt_pk_f16_f32 v46, v96, -v97
  ds_write_b32 v36, v46 offset:49632
  v_pk_mul_f32 v[42:43], v[96:97], v[92:93] op_sel:[0,0] op_sel_hi:[1,0]
  v_pk_fma_f32 v[96:97], v[96:97], v[92:93], v[42:43] op_sel:[1,1,0] op_sel_hi:[0,1,1] neg_lo:[1,0,0]
  v_cvt_pk_f16_f32 v47, v98, -v99
  ds_write_b32 v36, v47 offset:50688
  v_pk_mul_f32 v[44:45], v[98:99], v[92:93] op_sel:[0,0] op_sel_hi:[1,0]
  v_pk_fma_f32 v[98:99], v[98:99], v[92:93], v[44:45] op_sel:[1,1,0] op_sel_hi:[0,1,1] neg_lo:[1,0,0]
  v_cvt_pk_f16_f32 v46, v96, -v97
  ds_write_b32 v36, v46 offset:51744
  v_pk_mul_f32 v[42:43], v[96:97], v[92:93] op_sel:[0,0] op_sel_hi:[1,0]
  v_pk_fma_f32 v[96:97], v[96:97], v[92:93], v[42:43] op_sel:[1,1,0] op_sel_hi:[0,1,1] neg_lo:[1,0,0]
  v_cvt_pk_f16_f32 v47, v98, -v99
  ds_write_b32 v36, v47 offset:52800
  v_pk_mul_f32 v[44:45], v[98:99], v[92:93] op_sel:[0,0] op_sel_hi:[1,0]
  v_pk_fma_f32 v[98:99], v[98:99], v[92:93], v[44:45] op_sel:[1,1,0] op_sel_hi:[0,1,1] neg_lo:[1,0,0]
  v_cvt_pk_f16_f32 v46, v96, -v97
  ds_write_b32 v36, v46 offset:53856
  v_cvt_pk_f16_f32 v47, v98, -v99
  ds_write_b32 v36, v47 offset:54912
  v_mov_b32 v132, 0
  v_mov_b32 v133, 0
  v_mov_b32 v134, 0
  v_mov_b32 v135, 0
  s_waitcnt lgkmcnt(0)
  s_barrier
  s_cmp_lg_u32 s3, 0
  s_cbranch_scc1 A_NP1
  v_lshlrev_b32 v136, 6, v2
  s_mov_b32 s37, 131072
  buffer_load_dword v137, v136, s[28:31], s37 offen sc1
  s_mov_b32 s37, 135168
  buffer_load_dword v138, v136, s[28:31], s37 offen sc1
  s_mov_b32 s37, 139264
  buffer_load_dword v139, v136, s[28:31], s37 offen sc1
  s_mov_b32 s37, 143360
  buffer_load_dword v140, v136, s[28:31], s37 offen sc1
A_NP1:
  s_and_b32 s58, s44, 1
  s_lshr_b32 s59, s44, 1
  s_cmp_lt_u32 s3, 4
  s_cbranch_scc1 A_NOW
  s_cmp_eq_u32 s58, 0
  s_cselect_b32 s40, s20, s22
  s_cselect_b32 s41, s21, s23
  s_and_b32 s41, s41, 0xffff
  s_mov_b32 s42, 1605632
  s_mov_b32 s43, 0x20000
  v_lshrrev_b32 v22, 1, v2
  s_lshl_b32 s37, s46, 5
  v_add_u32 v22, s37, v22
  s_movk_i32 s37, 3584
  v_mul_lo_u32 v23, v22, s37
  v_and_b32 v141, 1, v2
  v_lshl_add_u32 v23, v141, 4, v23
  s_lshl_b32 s37, s59, 5
  v_add_u32 v23, s37, v23
  v_lshlrev_b32 v22, 2, v22
  s_mov_b32 s37, 0
  buffer_load_dwordx4 v[200:203], v23, s[40:43], s37 offen
  s_mov_b32 s37, 458752
  buffer_load_dwordx4 v[204:207], v23, s[40:43], s37 offen
  s_mov_b32 s37, 917504
  buffer_load_dwordx4 v[208:211], v23, s[40:43], s37 offen
  s_mov_b32 s37, 1376256
  buffer_load_dwordx4 v[212:215], v23, s[40:43], s37 offen
A_NOW:
  ds_read_b128 v[56:59], v37 offset:0
  ds_read_b128 v[60:63], v178 offset:0
  ds_read_b128 v[64:67], v37 offset:64
  ds_read_b128 v[68:71], v178 offset:64
  ds_read_b128 v[72:75], v37 offset:128
  ds_read_b128 v[76:79], v178 offset:128
  ds_read_b128 v[80:83], v37 offset:192
  ds_read_b128 v[84:87], v178 offset:192
  ds_read_b128 v[88:91], v37 offset:256
  ds_read_b128 v[92:95], v178 offset:256
  ds_read_b128 v[96:99], v37 offset:320
  ds_read_b128 v[100:103], v178 offset:320
  ds_read_b128 v[104:107], v37 offset:384
  ds_read_b128 v[108:111], v178 offset:384
  s_waitcnt lgkmcnt(12)
  v_mfma_f32_16x16x32_f16 v[132:135], v[56:59], v[60:63], v[132:135]
  ds_read_b128 v[112:115], v37 offset:448
  ds_read_b128 v[116:119], v178 offset:448
  s_waitcnt lgkmcnt(12)
  v_mfma_f32_16x16x32_f16 v[132:135], v[64:67], v[68:71], v[132:135]
  ds_read_b128 v[56:59], v37 offset:512
  ds_read_b128 v[60:63], v178 offset:512
  s_waitcnt lgkmcnt(12)
  v_mfma_f32_16x16x32_f16 v[132:135], v[72:75], v[76:79], v[132:135]
  ds_read_b128 v[64:67], v37 offset:576
  ds_read_b128 v[68:71], v178 offset:576
  s_waitcnt lgkmcnt(12)
  v_mfma_f32_16x16x32_f16 v[132:135], v[80:83], v[84:87], v[132:135]
  ds_read_b128 v[72:75], v37 offset:640
  ds_read_b128 v[76:79], v178 offset:640
  s_waitcnt lgkmcnt(12)
  v_mfma_f32_16x16x32_f16 v[132:135], v[88:91], v[92:95], v[132:135]
  ds_read_b128 v[80:83], v37 offset:704
  ds_read_b128 v[84:87], v178 offset:704
  s_waitcnt lgkmcnt(12)
  v_mfma_f32_16x16x32_f16 v[132:135], v[96:99], v[100:103], v[132:135]
  ds_read_b128 v[88:91], v37 offset:768
  ds_read_b128 v[92:95], v178 offset:768
  s_waitcnt lgkmcnt(12)
  v_mfma_f32_16x16x32_f16 v[132:135], v[104:107], v[108:111], v[132:135]
  ds_read_b128 v[96:99], v37 offset:832
  ds_read_b128 v[100:103], v178 offset:832
  s_waitcnt lgkmcnt(12)
  v_mfma_f32_16x16x32_f16 v[132:135], v[112:115], v[116:119], v[132:135]
  ds_read_b128 v[104:107], v37 offset:896
  ds_read_b128 v[108:111], v178 offset:896
  s_waitcnt lgkmcnt(12)
  v_mfma_f32_16x16x32_f16 v[132:135], v[56:59], v[60:63], v[132:135]
  ds_read_b128 v[112:115], v37 offset:960
  ds_read_b128 v[116:119], v178 offset:960
  s_waitcnt lgkmcnt(12)
  v_mfma_f32_16x16x32_f16 v[132:135], v[64:67], v[68:71], v[132:135]
  s_waitcnt lgkmcnt(10)
  v_mfma_f32_16x16x32_f16 v[132:135], v[72:75], v[76:79], v[132:135]
  s_waitcnt lgkmcnt(8)
  v_mfma_f32_16x16x32_f16 v[132:135], v[80:83], v[84:87], v[132:135]
  s_waitcnt lgkmcnt(6)
  v_mfma_f32_16x16x32_f16 v[132:135], v[88:91], v[92:95], v[132:135]
  s_waitcnt lgkmcnt(4)
  v_mfma_f32_16x16x32_f16 v[132:135], v[96:99], v[100:103], v[132:135]
  s_waitcnt lgkmcnt(2)
  v_mfma_f32_16x16x32_f16 v[132:135], v[104:107], v[108:111], v[132:135]
  s_waitcnt lgkmcnt(0)
  v_mfma_f32_16x16x32_f16 v[132:135], v[112:115], v[116:119], v[132:135]
  v_mov_b32 v29, 121424
  ds_write_b128 v29, v[24:27]
  ds_write_b128 v29, v[24:27] offset:9504
  s_nop 4
  ds_write_b32 v180, v132
  ds_write_b32 v181, v133
  ds_write_b32 v182, v134
  ds_write_b32 v183, v135
  s_cmp_lg_u32 s3, 0
  s_cbranch_scc1 A_NP2
  s_waitcnt vmcnt(0)
  v_and_b32 v137, v137, v138
  v_and_b32 v139, v139, v140
  v_and_b32 v137, v137, v139
  v_cmp_ne_u32 vcc, 1, v137
  s_nop 0
  s_cmp_eq_u64 vcc, 0
  s_cselect_b32 s37, 1, 0
  v_mov_b32 v136, 159776
  v_mov_b32 v137, s37
  ds_write_b32 v136, v137
A_NP2:
  v_mov_b32 v49, 159808
  s_lshl_b32 s37, s45, 3
  v_add_u32 v49, s37, v49
  v_mov_b32 v50, s56
  v_mov_b32 v51, v41
  ds_write_b64 v49, v[50:51]
  s_bfe_u32 s66, s3, 0x10001
  s_lshl_b32 s67, s44, 1
  s_add_u32 s67, s67, s66
  s_and_b32 s37, s3, 1
  s_lshl_b32 s37, s37, 6
  s_cmp_lt_u32 s3, 4
  s_cselect_b32 s38, 128, 0
  s_add_u32 s37, s37, s38
  v_add_u32 v8, s37, v2
  v_and_b32 v10, 0xfe, v8
  v_mul_u32_u24 v10, 14336, v10
  v_and_b32 v9, 1, v2
  v_lshl_add_u32 v10, v9, 4, v10
  v_lshlrev_b32 v9, 4, v8
  s_mul_i32 s37, s66, 4608
  s_add_u32 s37, s37, 67072
  v_add_u32 v9, s37, v9
  v_lshrrev_b32 v11, 2, v8
  v_mul_u32_u24 v11, 28672, v11
  v_and_b32 v12, 3, v8
  v_lshl_add_u32 v140, v12, 4, v11
  v_lshlrev_b32 v11, 4, v39
  s_lshl_b32 s37, s46, 7
  v_add_u32 v11, s37, v11
  v_lshrrev_b32 v12, 1, v11
  v_mov_b32 v136, 159776
  s_waitcnt lgkmcnt(0)
  s_barrier
  ds_read_b32 v137, v136
  ds_read_b32 v56, v160
  ds_read_b32 v57, v161
  ds_read_b32 v58, v162
  ds_read_b32 v59, v163
  ds_read_b32 v60, v164
  ds_read_b32 v61, v165
  ds_read_b32 v62, v166
  ds_read_b32 v63, v167
  ds_read_b32 v64, v168
  ds_read_b32 v65, v169
  ds_read_b32 v66, v170
  ds_read_b32 v67, v171
  ds_read_b32 v68, v172
  ds_read_b32 v69, v173
  ds_read_b32 v70, v174
  s_waitcnt lgkmcnt(15)
  v_readfirstlane_b32 s65, v137
  s_nop 0
  s_cmp_eq_u32 s65, 0
  s_mov_b32 s65, 0
  s_cbranch_scc1 A_LATE
  s_mov_b32 s65, 1
  s_lshl_b32 s37, s67, 5
  s_add_u32 s37, s37, 12582912
  s_add_u32 s38, s37, 14336
  buffer_load_dwordx4 v[124:127], v10, s[28:31], s37 offen sc1
  buffer_load_dwordx4 v[132:135], v10, s[28:31], s38 offen sc1
  s_lshl_b32 s37, s67, 2
  s_add_u32 s38, s37, 65536
  s_add_u32 s37, s37, 16384
  buffer_load_dword v129, v24, s[28:31], s37 offen sc1
  buffer_load_dword v128, v24, s[28:31], s38 offen offset:1792 sc1
  buffer_load_dword v142, v24, s[28:31], s37 offen offset:3584 sc1
  s_cmp_lg_u32 s3, 4
  s_cbranch_scc1 B_NTE
  v_lshlrev_b32 v11, 4, v2
  s_mov_b32 m0, 131456
  s_mov_b32 s37, 72704
  buffer_load_dwordx4 v11, s[28:31], s37 offen sc1 lds
  buffer_load_dwordx4 v11, s[28:31], s37 offen offset:1024 sc1 lds
  s_mov_b32 m0, 133504
  s_mov_b32 s37, 84608
  buffer_load_dwordx4 v11, s[28:31], s37 offen sc1 lds
B_NTE:
  s_branch A_LATE2
A_LATE:
  s_cmp_lg_u32 s3, 0
  s_cbranch_scc1 A_LATE2
  v_lshlrev_b32 v120, 6, v2
  s_mov_b32 s37, 131072
  buffer_load_dword v121, v120, s[28:31], s37 offen sc1
  s_mov_b32 s37, 135168
  buffer_load_dword v122, v120, s[28:31], s37 offen sc1
  s_mov_b32 s37, 139264
  buffer_load_dword v123, v120, s[28:31], s37 offen sc1
  s_mov_b32 s37, 143360
  buffer_load_dword v119, v120, s[28:31], s37 offen sc1
A_LATE2:
  v_and_b32 v48, 255, v0
  v_lshlrev_b32 v48, 4, v48
  s_mul_i32 s37, s45, 33280
  v_add_u32 v48, s37, v48
  v_lshlrev_b32 v49, 4, v0
  v_add_u32 v49, 66560, v49
  v_cmp_gt_u32 vcc, 32, v0
  s_nop 0
  s_and_saveexec_b64 s[38:39], vcc
  ds_write_b128 v49, v[24:27]
  ds_write_b128 v49, v[24:27] offset:4608
  s_mov_b64 exec, s[38:39]
  s_waitcnt lgkmcnt(0)
  v_cvt_pk_f16_f32 v72, v56, v57
  v_cvt_pk_f16_f32 v73, v58, v59
  v_cvt_pk_f16_f32 v74, v60, v61
  v_cvt_pk_f16_f32 v75, v62, v63
  v_cvt_pk_f16_f32 v76, v64, v65
  v_cvt_pk_f16_f32 v77, v66, v67
  ds_write_b128 v48, v[72:75] offset:0
  ds_write_b128 v48, v[74:77] offset:16640
  v_cvt_pk_f16_f32 v80, v58, v59
  v_cvt_pk_f16_f32 v81, v60, v61
  v_cvt_pk_f16_f32 v82, v62, v63
  v_cvt_pk_f16_f32 v83, v64, v65
  v_cvt_pk_f16_f32 v84, v66, v67
  v_cvt_pk_f16_f32 v85, v68, v69
  ds_write_b128 v48, v[80:83] offset:8320
  ds_write_b128 v48, v[82:85] offset:24960
  v_cvt_pk_f16_f32 v88, v57, v58
  v_cvt_pk_f16_f32 v89, v59, v60
  v_cvt_pk_f16_f32 v90, v61, v62
  v_cvt_pk_f16_f32 v91, v63, v64
  v_cvt_pk_f16_f32 v92, v65, v66
  v_cvt_pk_f16_f32 v93, v67, v68
  ds_write_b128 v48, v[88:91] offset:4160
  ds_write_b128 v48, v[90:93] offset:20800
  v_cvt_pk_f16_f32 v96, v59, v60
  v_cvt_pk_f16_f32 v97, v61, v62
  v_cvt_pk_f16_f32 v98, v63, v64
  v_cvt_pk_f16_f32 v99, v65, v66
  v_cvt_pk_f16_f32 v100, v67, v68
  v_cvt_pk_f16_f32 v101, v69, v70
  ds_write_b128 v48, v[96:99] offset:12480
  ds_write_b128 v48, v[98:101] offset:29120
  s_movk_i32 s37, 4160
  v_mul_lo_u32 v49, v0, s37
  v_cmp_gt_u32 vcc, 16, v0
  s_nop 0
  s_and_saveexec_b64 s[38:39], vcc
  ds_write_b128 v49, v[24:27] offset:4096
  s_mov_b64 exec, s[38:39]
  s_waitcnt lgkmcnt(0)
  s_cmp_lg_u32 s65, 0
  s_cbranch_scc1 B_GO
  s_cmp_lg_u32 s3, 0
  s_cbranch_scc1 B_W
  s_waitcnt vmcnt(0)
  v_and_b32 v121, v121, v122
  v_and_b32 v123, v123, v119
  v_and_b32 v121, v121, v123
  v_cmp_ne_u32 vcc, 1, v121
  s_nop 0
  s_cmp_eq_u64 vcc, 0
  s_cbranch_scc1 B_W
  v_lshlrev_b32 v104, 6, v2
  s_mov_b32 s38, 0
  s_mov_b64 s[40:41], -1
  s_mov_b64 s[42:43], -1
  s_mov_b64 s[76:77], -1
  s_mov_b64 s[78:79], -1
PA_4:
  s_mov_b64 exec, s[40:41]
  s_cbranch_execz PA_4_0
  s_mov_b32 s39, 131072
  buffer_load_dword v105, v104, s[28:31], s39 offen sc1
PA_4_0:
  s_mov_b64 exec, s[42:43]
  s_cbranch_execz PA_4_1
  s_mov_b32 s39, 135168
  buffer_load_dword v106, v104, s[28:31], s39 offen sc1
PA_4_1:
  s_mov_b64 exec, s[76:77]
  s_cbranch_execz PA_4_2
  s_mov_b32 s39, 139264
  buffer_load_dword v107, v104, s[28:31], s39 offen sc1
PA_4_2:
  s_mov_b64 exec, s[78:79]
  s_cbranch_execz PA_4_3
  s_mov_b32 s39, 143360
  buffer_load_dword v108, v104, s[28:31], s39 offen sc1
PA_4_3:
  s_mov_b64 exec, -1
  s_waitcnt vmcnt(0)
  v_cmp_ne_u32 vcc, 1, v105
  s_nop 0
  s_and_b64 s[40:41], s[40:41], vcc
  v_cmp_ne_u32 vcc, 1, v106
  s_nop 0
  s_and_b64 s[42:43], s[42:43], vcc
  v_cmp_ne_u32 vcc, 1, v107
  s_nop 0
  s_and_b64 s[76:77], s[76:77], vcc
  v_cmp_ne_u32 vcc, 1, v108
  s_nop 0
  s_and_b64 s[78:79], s[78:79], vcc
  s_or_b64 vcc, s[40:41], s[42:43]
  s_or_b64 vcc, vcc, s[76:77]
  s_or_b64 vcc, vcc, s[78:79]
  s_cbranch_scc0 PA_4D
  s_sleep 4
  s_add_u32 s38, s38, 1
  s_cmp_lt_u32 s38, 60000
  s_cbranch_scc1 PA_4
PA_4D:
B_W:
  s_barrier
  s_lshl_b32 s37, s67, 5
  s_add_u32 s37, s37, 12582912
  s_add_u32 s38, s37, 14336
  buffer_load_dwordx4 v[124:127], v10, s[28:31], s37 offen sc1
  buffer_load_dwordx4 v[132:135], v10, s[28:31], s38 offen sc1
  s_lshl_b32 s37, s67, 2
  s_add_u32 s38, s37, 65536
  s_add_u32 s37, s37, 16384
  buffer_load_dword v129, v24, s[28:31], s37 offen sc1
  buffer_load_dword v128, v24, s[28:31], s38 offen offset:1792 sc1
  buffer_load_dword v142, v24, s[28:31], s37 offen offset:3584 sc1
  s_cmp_lg_u32 s3, 4
  s_cbranch_scc1 B_NTL
  v_lshlrev_b32 v11, 4, v2
  s_mov_b32 m0, 131456
  s_mov_b32 s37, 72704
  buffer_load_dwordx4 v11, s[28:31], s37 offen sc1 lds
  buffer_load_dwordx4 v11, s[28:31], s37 offen offset:1024 sc1 lds
  s_mov_b32 m0, 133504
  s_mov_b32 s37, 84608
  buffer_load_dwordx4 v11, s[28:31], s37 offen sc1 lds
B_NTL:
B_GO:
  v_mov_b32 v49, 159808
  s_lshl_b32 s37, s66, 3
  v_add_u32 v49, s37, v49
  ds_read_b64 v[60:61], v49
  s_lshl_b32 s37, s66, 4
  s_lshr_b32 s37, s49, s37
  s_lshl_b32 s39, s37, 16
  s_waitcnt vmcnt(0) lgkmcnt(0)
  v_mov_b32 v52, v128
  v_mov_b32 v54, v129
  v_and_b32 v62, 1, v2
  v_cmp_eq_u32 vcc, 1, v62
  s_nop 1
  v_cndmask_b32 v64, v132, v124, vcc
  v_cndmask_b32 v65, v133, v125, vcc
  v_cndmask_b32 v66, v134, v126, vcc
  v_cndmask_b32 v67, v135, v127, vcc
  v_mov_b32_dpp v68, v64 quad_perm:[1,0,3,2] row_mask:0xf bank_mask:0xf
  v_mov_b32_dpp v69, v65 quad_perm:[1,0,3,2] row_mask:0xf bank_mask:0xf
  v_mov_b32_dpp v70, v66 quad_perm:[1,0,3,2] row_mask:0xf bank_mask:0xf
  v_mov_b32_dpp v71, v67 quad_perm:[1,0,3,2] row_mask:0xf bank_mask:0xf
  v_cndmask_b32 v64, v124, v68, vcc
  v_cndmask_b32 v124, v68, v132, vcc
  v_mov_b32 v132, v64
  v_cndmask_b32 v65, v125, v69, vcc
  v_cndmask_b32 v125, v69, v133, vcc
  v_mov_b32 v133, v65
  v_cndmask_b32 v66, v126, v70, vcc
  v_cndmask_b32 v126, v70, v134, vcc
  v_mov_b32 v134, v66
  v_cndmask_b32 v67, v127, v71, vcc
  v_cndmask_b32 v127, v71, v135, vcc
  v_mov_b32 v135, v67
  v_mul_f32 v50, 0x42400000, v52
  v_add_f32 v50, abs(v50), abs(v54)
  v_frexp_exp_i32_f32 v50, v50
  v_sub_u32 v51, 15, v50
  v_ldexp_f32 v53, 1.0, v51
  v_add_u32 v50, v60, v50
  v_add_u32 v50, -20, v50
  v_ldexp_f32 v141, v61, v50
  v_lshlrev_b32 v76, 16, v124
  v_and_b32 v77, 0xffff0000, v124
  v_mul_f32 v76, v76, v52
  v_mul_f32 v77, v77, v52
  v_cvt_pk_bf16_f32 v78, v76, v77
  v_lshlrev_b32 v76, 16, v78
  v_and_b32 v77, 0xffff0000, v78
  v_add_f32 v76, v76, v54
  v_add_f32 v77, v77, v54
  v_cvt_pk_bf16_f32 v78, v76, v77
  v_lshlrev_b32 v76, 16, v78
  v_and_b32 v77, 0xffff0000, v78
  v_mul_f32 v80, v76, v53
  v_mul_f32 v81, v77, v53
  v_cvt_pk_f16_f32 v72, v80, v81
  v_mul_f32 v76, s39, v76
  v_mul_f32 v77, s39, v77
  v_cvt_pk_bf16_f32 v136, v76, v77
  v_lshlrev_b32 v84, 16, v125
  v_and_b32 v85, 0xffff0000, v125
  v_mul_f32 v84, v84, v52
  v_mul_f32 v85, v85, v52
  v_cvt_pk_bf16_f32 v86, v84, v85
  v_lshlrev_b32 v84, 16, v86
  v_and_b32 v85, 0xffff0000, v86
  v_add_f32 v84, v84, v54
  v_add_f32 v85, v85, v54
  v_cvt_pk_bf16_f32 v86, v84, v85
  v_lshlrev_b32 v84, 16, v86
  v_and_b32 v85, 0xffff0000, v86
  v_mul_f32 v88, v84, v53
  v_mul_f32 v89, v85, v53
  v_cvt_pk_f16_f32 v73, v88, v89
  v_mul_f32 v84, s39, v84
  v_mul_f32 v85, s39, v85
  v_cvt_pk_bf16_f32 v137, v84, v85
  v_lshlrev_b32 v76, 16, v126
  v_and_b32 v77, 0xffff0000, v126
  v_mul_f32 v76, v76, v52
  v_mul_f32 v77, v77, v52
  v_cvt_pk_bf16_f32 v78, v76, v77
  v_lshlrev_b32 v76, 16, v78
  v_and_b32 v77, 0xffff0000, v78
  v_add_f32 v76, v76, v54
  v_add_f32 v77, v77, v54
  v_cvt_pk_bf16_f32 v78, v76, v77
  v_lshlrev_b32 v76, 16, v78
  v_and_b32 v77, 0xffff0000, v78
  v_mul_f32 v80, v76, v53
  v_mul_f32 v81, v77, v53
  v_cvt_pk_f16_f32 v74, v80, v81
  v_mul_f32 v76, s39, v76
  v_mul_f32 v77, s39, v77
  v_cvt_pk_bf16_f32 v138, v76, v77
  v_lshlrev_b32 v84, 16, v127
  v_and_b32 v85, 0xffff0000, v127
  v_mul_f32 v84, v84, v52
  v_mul_f32 v85, v85, v52
  v_cvt_pk_bf16_f32 v86, v84, v85
  v_lshlrev_b32 v84, 16, v86
  v_and_b32 v85, 0xffff0000, v86
  v_add_f32 v84, v84, v54
  v_add_f32 v85, v85, v54
  v_cvt_pk_bf16_f32 v86, v84, v85
  v_lshlrev_b32 v84, 16, v86
  v_and_b32 v85, 0xffff0000, v86
  v_mul_f32 v88, v84, v53
  v_mul_f32 v89, v85, v53
  v_cvt_pk_f16_f32 v75, v88, v89
  v_mul_f32 v84, s39, v84
  v_mul_f32 v85, s39, v85
  v_cvt_pk_bf16_f32 v139, v84, v85
  ds_write_b128 v9, v[72:75]
  s_waitcnt lgkmcnt(0)
  s_barrier
  s_and_b32 s4, s2, 7
  s_lshr_b32 s5, s2, 3
  s_lshr_b32 s6, s4, 2
  s_lshl_b32 s6, s6, 3
  s_and_b32 s37, s5, 7
  s_add_u32 s6, s6, s37
  s_and_b32 s7, s4, 3
  s_lshl_b32 s7, s7, 2
  s_lshr_b32 s37, s5, 3
  s_add_u32 s7, s7, s37
  s_mul_i32 s8, s7, 7
  s_add_u32 s8, s8, s3
  s_lshl_b32 s20, s4, 2
  s_and_b32 s37, s5, 3
  s_add_u32 s20, s20, s37
  s_lshr_b32 s21, s5, 2
  s_lshl_b32 s37, s37, 1
  s_add_u32 s22, s37, s21
  s_add_u32 s22, s22, s3
  s_and_b32 s22, s22, 7
  s_mul_i32 s23, s22, 14336
  s_mul_i32 s24, s21, 229376
  s_add_u32 s24, s24, s23
  s_add_u32 s24, s24, 8388608
  s_cmp_ge_u32 s2, 224
  s_cselect_b32 s24, 8388608, s24
  s_mul_i32 s12, s8, 28672
  s_add_u32 s12, s12, 4194304
  v_lshlrev_b32 v106, 4, v2
  v_and_b32 v104, 1, v2
  s_min_u32 s37, s8, 111
  s_lshl_b32 s37, s37, 1
  v_add_u32 v104, s37, v104
  s_mov_b32 s37, 153391690
  v_mul_hi_u32 v105, v104, s37
  v_mul_u32_u24 v107, 28, v105
  v_sub_u32 v107, v104, v107
  v_lshl_add_u32 v107, v107, 3, v105
  v_lshlrev_b32 v107, 6, v107
  s_mov_b32 s19, 0
  s_cmp_ge_u32 s3, 4
  s_cbranch_scc1 B_PREP
  s_setprio 1
  s_lshr_b32 s52, s3, 1
  s_and_b32 s53, s3, 1
  v_and_b32 v4, 15, v2
  v_lshrrev_b32 v5, 4, v2
  v_sub_u32 v6, 7, v4
  v_and_b32 v6, 7, v6
  s_movk_i32 s37, 4160
  v_mul_lo_u32 v6, v6, s37
  v_lshrrev_b32 v7, 3, v4
  v_sub_u32 v7, v5, v7
  v_lshl_add_u32 v6, v7, 4, v6
  s_mul_i32 s37, s52, 33280
  s_add_u32 s37, s37, 272
  s_lshl_b32 s38, s53, 8
  s_sub_u32 s37, s37, s38
  v_add_u32 v6, s37, v6
  v_lshlrev_b32 v7, 5, v4
  v_lshl_add_u32 v7, v5, 4, v7
  s_mul_i32 s37, s52, 4608
  s_add_u32 s37, s37, 66848
  s_sub_u32 s37, s37, s38
  v_add_u32 v7, s37, v7
  ds_read_b128 v[40:43], v6 offset:3776
  ds_read_b128 v[56:59], v7 offset:192
  ds_read_b128 v[44:47], v6 offset:3264
  ds_read_b128 v[60:63], v7 offset:704
  ds_read_b128 v[48:51], v6 offset:2752
  ds_read_b128 v[64:67], v7 offset:1216
  ds_read_b128 v[52:55], v6 offset:2240
  ds_read_b128 v[68:71], v7 offset:1728
  v_mov_b32 v8, 0
  v_mov_b32 v9, 0
  v_mov_b32 v10, 0
  v_mov_b32 v11, 0
  v_mov_b32 v12, 0
  v_mov_b32 v13, 0
  v_mov_b32 v14, 0
  v_mov_b32 v15, 0
  v_mov_b32 v16, 0
  v_mov_b32 v17, 0
  v_mov_b32 v18, 0
  v_mov_b32 v19, 0
  v_mov_b32 v20, 0
  v_mov_b32 v21, 0
  v_mov_b32 v22, 0
  v_mov_b32 v23, 0
  v_mov_b32 v24, 0
  v_mov_b32 v25, 0
  v_mov_b32 v26, 0
  v_mov_b32 v27, 0
  v_mov_b32 v28, 0
  v_mov_b32 v29, 0
  v_mov_b32 v30, 0
  v_mov_b32 v31, 0
  v_mov_b32 v32, 0
  v_mov_b32 v33, 0
  v_mov_b32 v34, 0
  v_mov_b32 v35, 0
  v_mov_b32 v36, 0
  v_mov_b32 v37, 0
  v_mov_b32 v38, 0
  v_mov_b32 v39, 0
  v_lshl_add_u32 v143, v4, 2, v5
  v_lshrrev_b32 v104, 3, v143
  v_xor_b32 v143, v143, v104
  s_lshl_b32 s37, s3, 12
  s_add_u32 s37, s37, 75776
  v_lshl_add_u32 v143, v143, 4, s37
  s_waitcnt lgkmcnt(6)
  v_mfma_f32_16x16x32_f16 v[8:11], v[40:43], v[56:59], v[8:11]
  s_waitcnt lgkmcnt(4)
  v_mfma_f32_16x16x32_f16 v[12:15], v[40:43], v[60:63], v[12:15]
  ds_read_b128 v[72:75], v6 offset:3712
  v_mfma_f32_16x16x32_f16 v[12:15], v[44:47], v[56:59], v[12:15]
  ds_read_b128 v[88:91], v7 offset:128
  s_waitcnt lgkmcnt(4)
  v_mfma_f32_16x16x32_f16 v[16:19], v[40:43], v[64:67], v[16:19]
  ds_read_b128 v[76:79], v6 offset:3200
  v_mfma_f32_16x16x32_f16 v[16:19], v[44:47], v[60:63], v[16:19]
  ds_read_b128 v[92:95], v7 offset:640
  v_mfma_f32_16x16x32_f16 v[16:19], v[48:51], v[56:59], v[16:19]
  ds_read_b128 v[80:83], v6 offset:2688
  s_waitcnt lgkmcnt(5)
  v_mfma_f32_16x16x32_f16 v[20:23], v[40:43], v[68:71], v[20:23]
  ds_read_b128 v[96:99], v7 offset:1152
  v_mfma_f32_16x16x32_f16 v[20:23], v[44:47], v[64:67], v[20:23]
  ds_read_b128 v[84:87], v6 offset:2176
  v_mfma_f32_16x16x32_f16 v[20:23], v[48:51], v[60:63], v[20:23]
  ds_read_b128 v[100:103], v7 offset:1664
  v_mfma_f32_16x16x32_f16 v[20:23], v[52:55], v[56:59], v[20:23]
  s_waitcnt lgkmcnt(6)
  v_mfma_f32_16x16x32_f16 v[8:11], v[72:75], v[88:91], v[8:11]
  ds_read_b128 v[40:43], v6 offset:3648
  s_waitcnt lgkmcnt(5)
  v_mfma_f32_16x16x32_f16 v[12:15], v[72:75], v[92:95], v[12:15]
  ds_read_b128 v[56:59], v7 offset:64
  v_mfma_f32_16x16x32_f16 v[12:15], v[76:79], v[88:91], v[12:15]
  ds_read_b128 v[44:47], v6 offset:3136
  s_waitcnt lgkmcnt(5)
  v_mfma_f32_16x16x32_f16 v[16:19], v[72:75], v[96:99], v[16:19]
  ds_read_b128 v[60:63], v7 offset:576
  v_mfma_f32_16x16x32_f16 v[16:19], v[76:79], v[92:95], v[16:19]
  ds_read_b128 v[48:51], v6 offset:2624
  v_mfma_f32_16x16x32_f16 v[16:19], v[80:83], v[88:91], v[16:19]
  ds_read_b128 v[64:67], v7 offset:1088
  s_waitcnt lgkmcnt(6)
  v_mfma_f32_16x16x32_f16 v[20:23], v[72:75], v[100:103], v[20:23]
  ds_read_b128 v[52:55], v6 offset:2112
  v_mfma_f32_16x16x32_f16 v[20:23], v[76:79], v[96:99], v[20:23]
  ds_read_b128 v[68:71], v7 offset:1600
  v_mfma_f32_16x16x32_f16 v[20:23], v[80:83], v[92:95], v[20:23]
  v_mfma_f32_16x16x32_f16 v[20:23], v[84:87], v[88:91], v[20:23]
  s_waitcnt lgkmcnt(6)
  v_mfma_f32_16x16x32_f16 v[8:11], v[40:43], v[56:59], v[8:11]
  ds_read_b128 v[72:75], v6 offset:3584
  s_waitcnt lgkmcnt(5)
  v_mfma_f32_16x16x32_f16 v[12:15], v[40:43], v[60:63], v[12:15]
  ds_read_b128 v[88:91], v7 offset:0
  v_mfma_f32_16x16x32_f16 v[12:15], v[44:47], v[56:59], v[12:15]
  ds_read_b128 v[76:79], v6 offset:3072
  s_waitcnt lgkmcnt(5)
  v_mfma_f32_16x16x32_f16 v[16:19], v[40:43], v[64:67], v[16:19]
  ds_read_b128 v[92:95], v7 offset:512
  v_mfma_f32_16x16x32_f16 v[16:19], v[44:47], v[60:63], v[16:19]
  ds_read_b128 v[80:83], v6 offset:2560
  v_mfma_f32_16x16x32_f16 v[16:19], v[48:51], v[56:59], v[16:19]
  ds_read_b128 v[96:99], v7 offset:1024
  s_waitcnt lgkmcnt(6)
  v_mfma_f32_16x16x32_f16 v[20:23], v[40:43], v[68:71], v[20:23]
  ds_read_b128 v[84:87], v6 offset:2048
  v_mfma_f32_16x16x32_f16 v[20:23], v[44:47], v[64:67], v[20:23]
  ds_read_b128 v[100:103], v7 offset:1536
  v_mfma_f32_16x16x32_f16 v[20:23], v[48:51], v[60:63], v[20:23]
  v_mfma_f32_16x16x32_f16 v[20:23], v[52:55], v[56:59], v[20:23]
  s_waitcnt lgkmcnt(6)
  v_mfma_f32_16x16x32_f16 v[8:11], v[72:75], v[88:91], v[8:11]
  ds_read_b128 v[40:43], v6 offset:3776
  s_waitcnt lgkmcnt(5)
  v_mfma_f32_16x16x32_f16 v[12:15], v[72:75], v[92:95], v[12:15]
  ds_read_b128 v[44:47], v6 offset:3264
  v_mfma_f32_16x16x32_f16 v[12:15], v[76:79], v[88:91], v[12:15]
  ds_read_b128 v[48:51], v6 offset:2752
  s_waitcnt lgkmcnt(5)
  v_mfma_f32_16x16x32_f16 v[16:19], v[72:75], v[96:99], v[16:19]
  ds_read_b128 v[52:55], v6 offset:2240
  v_mfma_f32_16x16x32_f16 v[16:19], v[76:79], v[92:95], v[16:19]
  ds_read_b128 v[56:59], v6 offset:1728
  v_mfma_f32_16x16x32_f16 v[16:19], v[80:83], v[88:91], v[16:19]
  ds_read_b128 v[60:63], v6 offset:1216
  s_waitcnt lgkmcnt(6)
  v_mfma_f32_16x16x32_f16 v[20:23], v[72:75], v[100:103], v[20:23]
  ds_read_b128 v[64:67], v6 offset:704
  v_mfma_f32_16x16x32_f16 v[20:23], v[76:79], v[96:99], v[20:23]
  ds_read_b128 v[68:71], v6 offset:192
  v_mfma_f32_16x16x32_f16 v[20:23], v[80:83], v[92:95], v[20:23]
  v_mfma_f32_16x16x32_f16 v[20:23], v[84:87], v[88:91], v[20:23]
  ds_read_b128 v[100:103], v7 offset:3776
  ds_read_b128 v[96:99], v7 offset:3264
  ds_read_b128 v[92:95], v7 offset:2752
  ds_read_b128 v[88:91], v7 offset:2240
  ds_read_b128 v[84:87], v7 offset:1728
  ds_read_b128 v[80:83], v7 offset:1216
  ds_read_b128 v[76:79], v7 offset:704
  ds_read_b128 v[72:75], v7 offset:192
  ds_write_b128 v143, v[8:11] offset:0
  ds_write_b128 v143, v[12:15] offset:1024
  ds_write_b128 v143, v[16:19] offset:2048
  ds_write_b128 v143, v[20:23] offset:3072
  s_waitcnt lgkmcnt(11)
  v_mfma_f32_16x16x32_f16 v[36:39], v[40:43], v[100:103], v[36:39]
  ds_read_b128 v[100:103], v7 offset:3712
  s_waitcnt lgkmcnt(11)
  v_mfma_f32_16x16x32_f16 v[32:35], v[40:43], v[96:99], v[32:35]
  s_waitcnt lgkmcnt(10)
  v_mfma_f32_16x16x32_f16 v[28:31], v[40:43], v[92:95], v[28:31]
  s_waitcnt lgkmcnt(9)
  v_mfma_f32_16x16x32_f16 v[24:27], v[40:43], v[88:91], v[24:27]
  ds_read_b128 v[40:43], v6 offset:3712
  v_mfma_f32_16x16x32_f16 v[36:39], v[44:47], v[96:99], v[36:39]
  ds_read_b128 v[96:99], v7 offset:3200
  s_waitcnt lgkmcnt(0)
  s_mov_b64 exec, 1
  v_mov_b32 v104, 159768
  v_mov_b32 v105, 1
  ds_add_u32 v104, v105
  s_mov_b64 exec, -1
  v_mfma_f32_16x16x32_f16 v[32:35], v[44:47], v[92:95], v[32:35]
  v_mfma_f32_16x16x32_f16 v[28:31], v[44:47], v[88:91], v[28:31]
  v_mfma_f32_16x16x32_f16 v[24:27], v[44:47], v[84:87], v[24:27]
  ds_read_b128 v[44:47], v6 offset:3200
  v_mfma_f32_16x16x32_f16 v[36:39], v[48:51], v[92:95], v[36:39]
  ds_read_b128 v[92:95], v7 offset:2688
  v_mfma_f32_16x16x32_f16 v[32:35], v[48:51], v[88:91], v[32:35]
  v_mfma_f32_16x16x32_f16 v[28:31], v[48:51], v[84:87], v[28:31]
  v_mfma_f32_16x16x32_f16 v[24:27], v[48:51], v[80:83], v[24:27]
  ds_read_b128 v[48:51], v6 offset:2688
  v_mfma_f32_16x16x32_f16 v[36:39], v[52:55], v[88:91], v[36:39]
  ds_read_b128 v[88:91], v7 offset:2176
  v_mfma_f32_16x16x32_f16 v[32:35], v[52:55], v[84:87], v[32:35]
  v_mfma_f32_16x16x32_f16 v[28:31], v[52:55], v[80:83], v[28:31]
  v_mfma_f32_16x16x32_f16 v[24:27], v[52:55], v[76:79], v[24:27]
  ds_read_b128 v[52:55], v6 offset:2176
  v_mfma_f32_16x16x32_f16 v[36:39], v[56:59], v[84:87], v[36:39]
  ds_read_b128 v[84:87], v7 offset:1664
  v_mfma_f32_16x16x32_f16 v[32:35], v[56:59], v[80:83], v[32:35]
  v_mfma_f32_16x16x32_f16 v[28:31], v[56:59], v[76:79], v[28:31]
  v_mfma_f32_16x16x32_f16 v[24:27], v[56:59], v[72:75], v[24:27]
  ds_read_b128 v[56:59], v6 offset:1664
  v_mfma_f32_16x16x32_f16 v[36:39], v[60:63], v[80:83], v[36:39]
  ds_read_b128 v[80:83], v7 offset:1152
  v_mfma_f32_16x16x32_f16 v[32:35], v[60:63], v[76:79], v[32:35]
  v_mfma_f32_16x16x32_f16 v[28:31], v[60:63], v[72:75], v[28:31]
  ds_read_b128 v[60:63], v6 offset:1152
  v_mfma_f32_16x16x32_f16 v[36:39], v[64:67], v[76:79], v[36:39]
  ds_read_b128 v[76:79], v7 offset:640
  v_mfma_f32_16x16x32_f16 v[32:35], v[64:67], v[72:75], v[32:35]
  ds_read_b128 v[64:67], v6 offset:640
  v_mfma_f32_16x16x32_f16 v[36:39], v[68:71], v[72:75], v[36:39]
  ds_read_b128 v[72:75], v7 offset:128
  ds_read_b128 v[68:71], v6 offset:128
  v_mfma_f32_16x16x32_f16 v[36:39], v[40:43], v[100:103], v[36:39]
  ds_read_b128 v[100:103], v7 offset:3648
  v_mfma_f32_16x16x32_f16 v[32:35], v[40:43], v[96:99], v[32:35]
  s_waitcnt lgkmcnt(12)
  v_mfma_f32_16x16x32_f16 v[28:31], v[40:43], v[92:95], v[28:31]
  s_waitcnt lgkmcnt(10)
  v_mfma_f32_16x16x32_f16 v[24:27], v[40:43], v[88:91], v[24:27]
  ds_read_b128 v[40:43], v6 offset:3648
  v_mfma_f32_16x16x32_f16 v[36:39], v[44:47], v[96:99], v[36:39]
  ds_read_b128 v[96:99], v7 offset:3136
  v_mfma_f32_16x16x32_f16 v[32:35], v[44:47], v[92:95], v[32:35]
  v_mfma_f32_16x16x32_f16 v[28:31], v[44:47], v[88:91], v[28:31]
  s_waitcnt lgkmcnt(10)
  v_mfma_f32_16x16x32_f16 v[24:27], v[44:47], v[84:87], v[24:27]
  ds_read_b128 v[44:47], v6 offset:3136
  v_mfma_f32_16x16x32_f16 v[36:39], v[48:51], v[92:95], v[36:39]
  ds_read_b128 v[92:95], v7 offset:2624
  v_mfma_f32_16x16x32_f16 v[32:35], v[48:51], v[88:91], v[32:35]
  v_mfma_f32_16x16x32_f16 v[28:31], v[48:51], v[84:87], v[28:31]
  s_waitcnt lgkmcnt(10)
  v_mfma_f32_16x16x32_f16 v[24:27], v[48:51], v[80:83], v[24:27]
  ds_read_b128 v[48:51], v6 offset:2624
  v_mfma_f32_16x16x32_f16 v[36:39], v[52:55], v[88:91], v[36:39]
  ds_read_b128 v[88:91], v7 offset:2112
  v_mfma_f32_16x16x32_f16 v[32:35], v[52:55], v[84:87], v[32:35]
  s_mov_b32 s37, 147456
  buffer_load_dword v105, v107, s[28:31], s37 offen sc1
  v_mfma_f32_16x16x32_f16 v[28:31], v[52:55], v[80:83], v[28:31]
  s_waitcnt lgkmcnt(10)
  v_mfma_f32_16x16x32_f16 v[24:27], v[52:55], v[76:79], v[24:27]
  ds_read_b128 v[52:55], v6 offset:2112
  v_mfma_f32_16x16x32_f16 v[36:39], v[56:59], v[84:87], v[36:39]
  ds_read_b128 v[84:87], v7 offset:1600
  v_mfma_f32_16x16x32_f16 v[32:35], v[56:59], v[80:83], v[32:35]
  v_mfma_f32_16x16x32_f16 v[28:31], v[56:59], v[76:79], v[28:31]
  s_waitcnt lgkmcnt(10)
  v_mfma_f32_16x16x32_f16 v[24:27], v[56:59], v[72:75], v[24:27]
  ds_read_b128 v[56:59], v6 offset:1600
  v_mfma_f32_16x16x32_f16 v[36:39], v[60:63], v[80:83], v[36:39]
  ds_read_b128 v[80:83], v7 offset:1088
  v_mfma_f32_16x16x32_f16 v[32:35], v[60:63], v[76:79], v[32:35]
  v_mfma_f32_16x16x32_f16 v[28:31], v[60:63], v[72:75], v[28:31]
  ds_read_b128 v[60:63], v6 offset:1088
  v_mfma_f32_16x16x32_f16 v[36:39], v[64:67], v[76:79], v[36:39]
  ds_read_b128 v[76:79], v7 offset:576
  v_mfma_f32_16x16x32_f16 v[32:35], v[64:67], v[72:75], v[32:35]
  ds_read_b128 v[64:67], v6 offset:576
  s_waitcnt lgkmcnt(14)
  v_mfma_f32_16x16x32_f16 v[36:39], v[68:71], v[72:75], v[36:39]
  ds_read_b128 v[72:75], v7 offset:64
  ds_read_b128 v[68:71], v6 offset:64
  s_waitcnt lgkmcnt(14)
  v_mfma_f32_16x16x32_f16 v[36:39], v[40:43], v[100:103], v[36:39]
  ds_read_b128 v[100:103], v7 offset:3584
  s_waitcnt lgkmcnt(14)
  v_mfma_f32_16x16x32_f16 v[32:35], v[40:43], v[96:99], v[32:35]
  s_waitcnt lgkmcnt(12)
  v_mfma_f32_16x16x32_f16 v[28:31], v[40:43], v[92:95], v[28:31]
  s_waitcnt lgkmcnt(10)
  v_mfma_f32_16x16x32_f16 v[24:27], v[40:43], v[88:91], v[24:27]
  ds_read_b128 v[40:43], v6 offset:3584
  v_mfma_f32_16x16x32_f16 v[36:39], v[44:47], v[96:99], v[36:39]
  ds_read_b128 v[96:99], v7 offset:3072
  v_mfma_f32_16x16x32_f16 v[32:35], v[44:47], v[92:95], v[32:35]
  v_mfma_f32_16x16x32_f16 v[28:31], v[44:47], v[88:91], v[28:31]
  s_waitcnt lgkmcnt(10)
  v_mfma_f32_16x16x32_f16 v[24:27], v[44:47], v[84:87], v[24:27]
  ds_read_b128 v[44:47], v6 offset:3072
  v_mfma_f32_16x16x32_f16 v[36:39], v[48:51], v[92:95], v[36:39]
  ds_read_b128 v[92:95], v7 offset:2560
  v_mfma_f32_16x16x32_f16 v[32:35], v[48:51], v[88:91], v[32:35]
  v_mfma_f32_16x16x32_f16 v[28:31], v[48:51], v[84:87], v[28:31]
  s_waitcnt lgkmcnt(10)
  v_mfma_f32_16x16x32_f16 v[24:27], v[48:51], v[80:83], v[24:27]
  ds_read_b128 v[48:51], v6 offset:2560
  v_mfma_f32_16x16x32_f16 v[36:39], v[52:55], v[88:91], v[36:39]
  ds_read_b128 v[88:91], v7 offset:2048
  v_mfma_f32_16x16x32_f16 v[32:35], v[52:55], v[84:87], v[32:35]
  v_mfma_f32_16x16x32_f16 v[28:31], v[52:55], v[80:83], v[28:31]
  s_waitcnt lgkmcnt(10)
  v_mfma_f32_16x16x32_f16 v[24:27], v[52:55], v[76:79], v[24:27]
  ds_read_b128 v[52:55], v6 offset:2048
  v_mfma_f32_16x16x32_f16 v[36:39], v[56:59], v[84:87], v[36:39]
  ds_read_b128 v[84:87], v7 offset:1536
  v_mfma_f32_16x16x32_f16 v[32:35], v[56:59], v[80:83], v[32:35]
  v_mfma_f32_16x16x32_f16 v[28:31], v[56:59], v[76:79], v[28:31]
  s_waitcnt lgkmcnt(10)
  v_mfma_f32_16x16x32_f16 v[24:27], v[56:59], v[72:75], v[24:27]
  ds_read_b128 v[56:59], v6 offset:1536
  v_mfma_f32_16x16x32_f16 v[36:39], v[60:63], v[80:83], v[36:39]
  ds_read_b128 v[80:83], v7 offset:1024
  v_mfma_f32_16x16x32_f16 v[32:35], v[60:63], v[76:79], v[32:35]
  s_waitcnt vmcnt(0)
  v_cmp_ne_u32 vcc, 1, v105
  s_nop 0
  s_and_b32 s37, vcc_lo, 3
  s_cmp_eq_u32 s37, 0
  s_mov_b32 s19, 0
  s_cbranch_scc0 B_NW
  s_mov_b32 s19, 1
B_NW:
  v_mfma_f32_16x16x32_f16 v[28:31], v[60:63], v[72:75], v[28:31]
  ds_read_b128 v[60:63], v6 offset:1024
  v_mfma_f32_16x16x32_f16 v[36:39], v[64:67], v[76:79], v[36:39]
  ds_read_b128 v[76:79], v7 offset:512
  s_cmp_eq_u32 s19, 0
  s_cbranch_scc1 AL_5
  s_add_u32 s37, s12, 0
  buffer_load_dwordx4 v[144:147], v106, s[28:31], s37 offen sc1
  s_add_u32 s37, s12, 1024
  buffer_load_dwordx4 v[148:151], v106, s[28:31], s37 offen sc1
AL_5:
  v_mfma_f32_16x16x32_f16 v[32:35], v[64:67], v[72:75], v[32:35]
  ds_read_b128 v[64:67], v6 offset:512
  s_waitcnt lgkmcnt(14)
  v_mfma_f32_16x16x32_f16 v[36:39], v[68:71], v[72:75], v[36:39]
  ds_read_b128 v[72:75], v7 offset:0
  s_cmp_eq_u32 s19, 0
  s_cbranch_scc1 AL_6
  s_add_u32 s37, s12, 2048
  buffer_load_dwordx4 v[152:155], v106, s[28:31], s37 offen sc1
  s_add_u32 s37, s12, 3072
  buffer_load_dwordx4 v[156:159], v106, s[28:31], s37 offen sc1
AL_6:
  ds_read_b128 v[68:71], v6 offset:0
  s_waitcnt lgkmcnt(14)
  v_mfma_f32_16x16x32_f16 v[36:39], v[40:43], v[100:103], v[36:39]
  s_waitcnt lgkmcnt(13)
  v_mfma_f32_16x16x32_f16 v[32:35], v[40:43], v[96:99], v[32:35]
  s_cmp_eq_u32 s19, 0
  s_cbranch_scc1 AL_7
  s_add_u32 s37, s12, 4096
  buffer_load_dwordx4 v[160:163], v106, s[28:31], s37 offen sc1
  s_add_u32 s37, s12, 5120
  buffer_load_dwordx4 v[164:167], v106, s[28:31], s37 offen sc1
AL_7:
  s_waitcnt lgkmcnt(11)
  v_mfma_f32_16x16x32_f16 v[28:31], v[40:43], v[92:95], v[28:31]
  s_waitcnt lgkmcnt(9)
  v_mfma_f32_16x16x32_f16 v[24:27], v[40:43], v[88:91], v[24:27]
  s_cmp_eq_u32 s19, 0
  s_cbranch_scc1 AL_8
  s_add_u32 s37, s12, 6144
  buffer_load_dwordx4 v[168:171], v106, s[28:31], s37 offen sc1
  s_add_u32 s37, s12, 7168
  buffer_load_dwordx4 v[172:175], v106, s[28:31], s37 offen sc1
AL_8:
  v_mfma_f32_16x16x32_f16 v[36:39], v[44:47], v[96:99], v[36:39]
  v_mfma_f32_16x16x32_f16 v[32:35], v[44:47], v[92:95], v[32:35]
  s_cmp_eq_u32 s19, 0
  s_cbranch_scc1 AL_9
  s_add_u32 s37, s12, 8192
  buffer_load_dwordx4 v[176:179], v106, s[28:31], s37 offen sc1
  s_add_u32 s37, s12, 9216
  buffer_load_dwordx4 v[180:183], v106, s[28:31], s37 offen sc1
AL_9:
  v_mfma_f32_16x16x32_f16 v[28:31], v[44:47], v[88:91], v[28:31]
  s_waitcnt lgkmcnt(7)
  v_mfma_f32_16x16x32_f16 v[24:27], v[44:47], v[84:87], v[24:27]
  s_cmp_eq_u32 s19, 0
  s_cbranch_scc1 AL_10
  s_add_u32 s37, s12, 10240
  buffer_load_dwordx4 v[184:187], v106, s[28:31], s37 offen sc1
  s_add_u32 s37, s12, 11264
  buffer_load_dwordx4 v[188:191], v106, s[28:31], s37 offen sc1
AL_10:
  v_mfma_f32_16x16x32_f16 v[36:39], v[48:51], v[92:95], v[36:39]
  v_mfma_f32_16x16x32_f16 v[32:35], v[48:51], v[88:91], v[32:35]
  s_cmp_eq_u32 s19, 0
  s_cbranch_scc1 AL_11
  s_add_u32 s37, s12, 12288
  buffer_load_dwordx4 v[192:195], v106, s[28:31], s37 offen sc1
  s_add_u32 s37, s12, 13312
  buffer_load_dwordx4 v[196:199], v106, s[28:31], s37 offen sc1
AL_11:
  v_mfma_f32_16x16x32_f16 v[28:31], v[48:51], v[84:87], v[28:31]
  s_waitcnt lgkmcnt(5)
  v_mfma_f32_16x16x32_f16 v[24:27], v[48:51], v[80:83], v[24:27]
  s_cmp_eq_u32 s19, 0
  s_cbranch_scc1 AL_12
  s_add_u32 s37, s12, 14336
  buffer_load_dwordx4 v[200:203], v106, s[28:31], s37 offen sc1
  s_add_u32 s37, s12, 15360
  buffer_load_dwordx4 v[204:207], v106, s[28:31], s37 offen sc1
AL_12:
  v_mfma_f32_16x16x32_f16 v[36:39], v[52:55], v[88:91], v[36:39]
  v_mfma_f32_16x16x32_f16 v[32:35], v[52:55], v[84:87], v[32:35]
  s_cmp_eq_u32 s19, 0
  s_cbranch_scc1 AL_13
  s_add_u32 s37, s12, 16384
  buffer_load_dwordx4 v[208:211], v106, s[28:31], s37 offen sc1
  s_add_u32 s37, s12, 17408
  buffer_load_dwordx4 v[212:215], v106, s[28:31], s37 offen sc1
AL_13:
  v_mfma_f32_16x16x32_f16 v[28:31], v[52:55], v[80:83], v[28:31]
  s_waitcnt lgkmcnt(3)
  v_mfma_f32_16x16x32_f16 v[24:27], v[52:55], v[76:79], v[24:27]
  s_cmp_eq_u32 s19, 0
  s_cbranch_scc1 AL_14
  s_add_u32 s37, s12, 18432
  buffer_load_dwordx4 v[216:219], v106, s[28:31], s37 offen sc1
  s_add_u32 s37, s12, 19456
  buffer_load_dwordx4 v[220:223], v106, s[28:31], s37 offen sc1
AL_14:
  v_mfma_f32_16x16x32_f16 v[36:39], v[56:59], v[84:87], v[36:39]
  v_mfma_f32_16x16x32_f16 v[32:35], v[56:59], v[80:83], v[32:35]
  s_cmp_eq_u32 s19, 0
  s_cbranch_scc1 AL_15
  s_add_u32 s37, s12, 20480
  buffer_load_dwordx4 v[224:227], v106, s[28:31], s37 offen sc1
  s_add_u32 s37, s12, 21504
  buffer_load_dwordx4 v[228:231], v106, s[28:31], s37 offen sc1
AL_15:
  v_mfma_f32_16x16x32_f16 v[28:31], v[56:59], v[76:79], v[28:31]
  s_waitcnt lgkmcnt(1)
  v_mfma_f32_16x16x32_f16 v[24:27], v[56:59], v[72:75], v[24:27]
  s_cmp_eq_u32 s19, 0
  s_cbranch_scc1 AL_16
  s_add_u32 s37, s12, 22528
  buffer_load_dwordx4 v[232:235], v106, s[28:31], s37 offen sc1
  s_add_u32 s37, s12, 23552
  buffer_load_dwordx4 v[236:239], v106, s[28:31], s37 offen sc1
AL_16:
  v_mfma_f32_16x16x32_f16 v[36:39], v[60:63], v[80:83], v[36:39]
  v_mfma_f32_16x16x32_f16 v[32:35], v[60:63], v[76:79], v[32:35]
  s_cmp_eq_u32 s19, 0
  s_cbranch_scc1 AL_17
  s_add_u32 s37, s12, 24576
  buffer_load_dwordx4 v[240:243], v106, s[28:31], s37 offen sc1
  s_add_u32 s37, s12, 25600
  buffer_load_dwordx4 v[244:247], v106, s[28:31], s37 offen sc1
AL_17:
  v_mfma_f32_16x16x32_f16 v[28:31], v[60:63], v[72:75], v[28:31]
  v_mfma_f32_16x16x32_f16 v[36:39], v[64:67], v[76:79], v[36:39]
  s_cmp_eq_u32 s19, 0
  s_cbranch_scc1 AL_18
  s_add_u32 s37, s12, 26624
  buffer_load_dwordx4 v[248:251], v106, s[28:31], s37 offen sc1
  s_add_u32 s37, s12, 27648
  buffer_load_dwordx4 v[252:255], v106, s[28:31], s37 offen sc1
AL_18:
  v_mfma_f32_16x16x32_f16 v[32:35], v[64:67], v[72:75], v[32:35]
  s_waitcnt lgkmcnt(0)
  v_mfma_f32_16x16x32_f16 v[36:39], v[68:71], v[72:75], v[36:39]
  s_setprio 0
  v_mov_b32 v104, 159780
  s_mov_b32 s38, 0
LS_19:
  ds_read_b32 v105, v104
  s_waitcnt lgkmcnt(0)
  v_readfirstlane_b32 s37, v105
  s_nop 0
  s_cmp_ge_u32 s37, 4
  s_cbranch_scc1 LS_19D
  s_sleep 1
  s_add_u32 s38, s38, 1
  s_cmp_lt_u32 s38, 960000
  s_cbranch_scc1 LS_19
LS_19D:
  ds_write_b128 v143, v[24:27] offset:0
  ds_write_b128 v143, v[28:31] offset:1024
  ds_write_b128 v143, v[32:35] offset:2048
  ds_write_b128 v143, v[36:39] offset:3072
  s_waitcnt lgkmcnt(0)
  s_mov_b64 exec, 1
  v_mov_b32 v104, 159772
  v_mov_b32 v105, 1
  ds_add_u32 v104, v105
  s_mov_b64 exec, -1
  v_mov_b32 v104, 159772
  s_mov_b32 s38, 0
LS_20:
  ds_read_b32 v105, v104
  s_waitcnt lgkmcnt(0)
  v_readfirstlane_b32 s37, v105
  s_nop 0
  s_cmp_ge_u32 s37, 4
  s_cbranch_scc1 LS_20D
  s_sleep 1
  s_add_u32 s38, s38, 1
  s_cmp_lt_u32 s38, 960000
  s_cbranch_scc1 LS_20
LS_20D:
  s_and_b32 s37, s3, 1
  s_lshl_b32 s37, s37, 6
  v_add_u32 v104, s37, v2
  v_lshlrev_b32 v104, 1, v104
  v_bfe_u32 v105, v104, 3, 3
  v_xor_b32 v104, v104, v105
  v_xor_b32 v105, 1, v104
  s_lshl_b32 s37, s66, 13
  s_add_u32 s37, s37, 75776
  v_lshl_add_u32 v104, v104, 4, s37
  v_lshl_add_u32 v105, v105, 4, s37
  ds_read_b128 v[108:111], v104
  ds_read_b128 v[116:119], v104 offset:4096
  ds_read_b128 v[112:115], v105
  ds_read_b128 v[120:123], v105 offset:4096
  s_lshl_b32 s37, s67, 6
  s_add_u32 s37, s37, 1048576
  s_waitcnt lgkmcnt(2)
  v_add_f32 v108, v108, v116
  v_add_f32 v109, v109, v117
  v_mul_f32 v108, v108, v141
  v_mul_f32 v109, v109, v141
  v_cvt_pk_bf16_f32 v126, v108, v109
  v_lshlrev_b32 v124, 16, v126
  v_and_b32 v125, 0xffff0000, v126
  v_lshlrev_b32 v127, 16, v136
  v_and_b32 v128, 0xffff0000, v136
  v_add_f32 v124, v124, v127
  v_add_f32 v125, v125, v128
  v_cvt_pk_bf16_f32 v126, v124, v125
  v_lshlrev_b32 v124, 16, v126
  v_and_b32 v125, 0xffff0000, v126
  v_mul_f32 v124, v124, v142
  v_mul_f32 v125, v125, v142
  v_cvt_pk_bf16_f32 v126, v124, v125
  v_lshlrev_b32 v124, 16, v126
  v_and_b32 v125, 0xffff0000, v126
  v_lshlrev_b32 v127, 16, v132
  v_and_b32 v128, 0xffff0000, v132
  v_add_f32 v124, v124, v127
  v_add_f32 v125, v125, v128
  v_cvt_pk_bf16_f32 v136, v124, v125
  v_add_f32 v110, v110, v118
  v_add_f32 v111, v111, v119
  v_mul_f32 v110, v110, v141
  v_mul_f32 v111, v111, v141
  v_cvt_pk_bf16_f32 v102, v110, v111
  v_lshlrev_b32 v100, 16, v102
  v_and_b32 v101, 0xffff0000, v102
  v_lshlrev_b32 v130, 16, v137
  v_and_b32 v131, 0xffff0000, v137
  v_add_f32 v100, v100, v130
  v_add_f32 v101, v101, v131
  v_cvt_pk_bf16_f32 v102, v100, v101
  v_lshlrev_b32 v100, 16, v102
  v_and_b32 v101, 0xffff0000, v102
  v_mul_f32 v100, v100, v142
  v_mul_f32 v101, v101, v142
  v_cvt_pk_bf16_f32 v102, v100, v101
  v_lshlrev_b32 v100, 16, v102
  v_and_b32 v101, 0xffff0000, v102
  v_lshlrev_b32 v130, 16, v133
  v_and_b32 v131, 0xffff0000, v133
  v_add_f32 v100, v100, v130
  v_add_f32 v101, v101, v131
  v_cvt_pk_bf16_f32 v137, v100, v101
  s_waitcnt lgkmcnt(0)
  v_add_f32 v112, v112, v120
  v_add_f32 v113, v113, v121
  v_mul_f32 v112, v112, v141
  v_mul_f32 v113, v113, v141
  v_cvt_pk_bf16_f32 v126, v112, v113
  v_lshlrev_b32 v124, 16, v126
  v_and_b32 v125, 0xffff0000, v126
  v_lshlrev_b32 v127, 16, v138
  v_and_b32 v128, 0xffff0000, v138
  v_add_f32 v124, v124, v127
  v_add_f32 v125, v125, v128
  v_cvt_pk_bf16_f32 v126, v124, v125
  v_lshlrev_b32 v124, 16, v126
  v_and_b32 v125, 0xffff0000, v126
  v_mul_f32 v124, v124, v142
  v_mul_f32 v125, v125, v142
  v_cvt_pk_bf16_f32 v126, v124, v125
  v_lshlrev_b32 v124, 16, v126
  v_and_b32 v125, 0xffff0000, v126
  v_lshlrev_b32 v127, 16, v134
  v_and_b32 v128, 0xffff0000, v134
  v_add_f32 v124, v124, v127
  v_add_f32 v125, v125, v128
  v_cvt_pk_bf16_f32 v138, v124, v125
  v_add_f32 v114, v114, v122
  v_add_f32 v115, v115, v123
  v_mul_f32 v114, v114, v141
  v_mul_f32 v115, v115, v141
  v_cvt_pk_bf16_f32 v102, v114, v115
  v_lshlrev_b32 v100, 16, v102
  v_and_b32 v101, 0xffff0000, v102
  v_lshlrev_b32 v130, 16, v139
  v_and_b32 v131, 0xffff0000, v139
  v_add_f32 v100, v100, v130
  v_add_f32 v101, v101, v131
  v_cvt_pk_bf16_f32 v102, v100, v101
  v_lshlrev_b32 v100, 16, v102
  v_and_b32 v101, 0xffff0000, v102
  v_mul_f32 v100, v100, v142
  v_mul_f32 v101, v101, v142
  v_cvt_pk_bf16_f32 v102, v100, v101
  v_lshlrev_b32 v100, 16, v102
  v_and_b32 v101, 0xffff0000, v102
  v_lshlrev_b32 v130, 16, v135
  v_and_b32 v131, 0xffff0000, v135
  v_add_f32 v100, v100, v130
  v_add_f32 v101, v101, v131
  v_cvt_pk_bf16_f32 v139, v100, v101
  buffer_store_dwordx4 v[136:139], v140, s[28:31], s37 offen sc1
  s_branch C_ENTRY
B_PREP:
  s_setprio 2
  s_lshl_b32 s37, s46, 12
  s_add_u32 s37, s37, 111936
  v_lshl_add_u32 v4, v2, 4, s37
  v_lshl_add_u32 v5, v2, 3, s37
  ds_write_b128 v4, v[200:203] offset:0
  ds_write_b128 v4, v[204:207] offset:1024
  ds_write_b128 v4, v[208:211] offset:2048
  ds_write_b128 v4, v[212:215] offset:3072
  v_mov_b32 v8, 0x3f803f80
  v_mov_b32 v9, 0x3f803f80
  v_mov_b32 v10, 0x3f803f80
  v_mov_b32 v11, 0x3f803f80
  v_lshlrev_b32 v36, 4, v39
  s_lshl_b32 s37, s46, 7
  s_add_u32 s37, s37, 131456
  v_add_u32 v36, s37, v36
  v_lshlrev_b32 v37, 3, v39
  s_lshl_b32 s37, s46, 6
  s_add_u32 s37, s37, 133504
  v_add_u32 v37, s37, v37
  v_lshrrev_b32 v6, 5, v2
  v_lshlrev_b32 v6, 10, v6
  v_bfe_u32 v7, v2, 4, 1
  v_lshl_add_u32 v6, v7, 9, v6
  v_and_b32 v7, 15, v2
  v_lshl_add_u32 v6, v7, 4, v6
  s_mul_i32 s54, s59, 28672
  s_lshl_b32 s37, s58, 8
  s_add_u32 s54, s54, s37
  s_lshl_b32 s37, s46, 11
  s_add_u32 s54, s54, s37
  s_add_u32 s54, s54, 4194304
  s_waitcnt lgkmcnt(0)
  ds_read_b64_tr_b16 v[200:201], v5 offset:0
  ds_read_b64_tr_b16 v[202:203], v5 offset:512
  ds_read_b128 v[48:51], v36 offset:0
  ds_read_b128 v[52:55], v36 offset:64
  ds_read2_b64 v[56:59], v37 offset0:0 offset1:4
  ds_read_b64_tr_b16 v[204:205], v5 offset:1024
  ds_read_b64_tr_b16 v[206:207], v5 offset:1536
  ds_read_b128 v[60:63], v36 offset:512
  ds_read_b128 v[64:67], v36 offset:576
  ds_read2_b64 v[68:71], v37 offset0:32 offset1:36
  ds_read_b64_tr_b16 v[208:209], v5 offset:2048
  ds_read_b64_tr_b16 v[210:211], v5 offset:2560
  ds_read_b128 v[72:75], v36 offset:1024
  ds_read_b128 v[76:79], v36 offset:1088
  ds_read2_b64 v[80:83], v37 offset0:64 offset1:68
  ds_read_b64_tr_b16 v[212:213], v5 offset:3072
  ds_read_b64_tr_b16 v[214:215], v5 offset:3584
  ds_read_b128 v[84:87], v36 offset:1536
  ds_read_b128 v[88:91], v36 offset:1600
  ds_read2_b64 v[92:95], v37 offset0:96 offset1:100
  v_mov_b32 v12, 0
  v_mov_b32 v13, 0
  v_mov_b32 v14, 0
  v_mov_b32 v15, 0
  v_mov_b32 v16, 0
  v_mov_b32 v17, 0
  v_mov_b32 v18, 0
  v_mov_b32 v19, 0
  s_waitcnt lgkmcnt(15)
  v_lshlrev_b32 v22, 16, v200
  v_and_b32 v23, 0xffff0000, v200
  v_mul_f32 v22, v22, v48
  v_mul_f32 v23, v23, v49
  v_cvt_pk_bf16_f32 v28, v22, v23
  v_lshlrev_b32 v22, 16, v201
  v_and_b32 v23, 0xffff0000, v201
  v_mul_f32 v22, v22, v50
  v_mul_f32 v23, v23, v51
  v_cvt_pk_bf16_f32 v29, v22, v23
  v_lshlrev_b32 v22, 16, v202
  v_and_b32 v23, 0xffff0000, v202
  v_mul_f32 v22, v22, v52
  v_mul_f32 v23, v23, v53
  v_cvt_pk_bf16_f32 v30, v22, v23
  v_lshlrev_b32 v22, 16, v203
  v_and_b32 v23, 0xffff0000, v203
  v_mul_f32 v22, v22, v54
  v_mul_f32 v23, v23, v55
  v_cvt_pk_bf16_f32 v31, v22, v23
  buffer_store_dwordx4 v[28:31], v6, s[28:31], s54 offen sc1
  v_mfma_f32_16x16x32_bf16 v[16:19], v[200:203], v[56:59], v[16:19]
  v_mfma_f32_16x16x32_bf16 v[12:15], v[28:31], v[8:11], v[12:15]
  s_add_u32 s54, s54, 8192
  s_waitcnt lgkmcnt(10)
  v_lshlrev_b32 v22, 16, v204
  v_and_b32 v23, 0xffff0000, v204
  v_mul_f32 v22, v22, v60
  v_mul_f32 v23, v23, v61
  v_cvt_pk_bf16_f32 v32, v22, v23
  v_lshlrev_b32 v22, 16, v205
  v_and_b32 v23, 0xffff0000, v205
  v_mul_f32 v22, v22, v62
  v_mul_f32 v23, v23, v63
  v_cvt_pk_bf16_f32 v33, v22, v23
  v_lshlrev_b32 v22, 16, v206
  v_and_b32 v23, 0xffff0000, v206
  v_mul_f32 v22, v22, v64
  v_mul_f32 v23, v23, v65
  v_cvt_pk_bf16_f32 v34, v22, v23
  v_lshlrev_b32 v22, 16, v207
  v_and_b32 v23, 0xffff0000, v207
  v_mul_f32 v22, v22, v66
  v_mul_f32 v23, v23, v67
  v_cvt_pk_bf16_f32 v35, v22, v23
  buffer_store_dwordx4 v[32:35], v6, s[28:31], s54 offen sc1
  v_mfma_f32_16x16x32_bf16 v[16:19], v[204:207], v[68:71], v[16:19]
  v_mfma_f32_16x16x32_bf16 v[12:15], v[32:35], v[8:11], v[12:15]
  s_add_u32 s54, s54, 8192
  s_waitcnt lgkmcnt(5)
  v_lshlrev_b32 v22, 16, v208
  v_and_b32 v23, 0xffff0000, v208
  v_mul_f32 v22, v22, v72
  v_mul_f32 v23, v23, v73
  v_cvt_pk_bf16_f32 v28, v22, v23
  v_lshlrev_b32 v22, 16, v209
  v_and_b32 v23, 0xffff0000, v209
  v_mul_f32 v22, v22, v74
  v_mul_f32 v23, v23, v75
  v_cvt_pk_bf16_f32 v29, v22, v23
  v_lshlrev_b32 v22, 16, v210
  v_and_b32 v23, 0xffff0000, v210
  v_mul_f32 v22, v22, v76
  v_mul_f32 v23, v23, v77
  v_cvt_pk_bf16_f32 v30, v22, v23
  v_lshlrev_b32 v22, 16, v211
  v_and_b32 v23, 0xffff0000, v211
  v_mul_f32 v22, v22, v78
  v_mul_f32 v23, v23, v79
  v_cvt_pk_bf16_f32 v31, v22, v23
  buffer_store_dwordx4 v[28:31], v6, s[28:31], s54 offen sc1
  v_mfma_f32_16x16x32_bf16 v[16:19], v[208:211], v[80:83], v[16:19]
  v_mfma_f32_16x16x32_bf16 v[12:15], v[28:31], v[8:11], v[12:15]
  s_add_u32 s54, s54, 8192
  s_cmp_ge_u32 s46, 2
  s_cbranch_scc1 B_PD
  s_waitcnt lgkmcnt(0)
  v_lshlrev_b32 v22, 16, v212
  v_and_b32 v23, 0xffff0000, v212
  v_mul_f32 v22, v22, v84
  v_mul_f32 v23, v23, v85
  v_cvt_pk_bf16_f32 v32, v22, v23
  v_lshlrev_b32 v22, 16, v213
  v_and_b32 v23, 0xffff0000, v213
  v_mul_f32 v22, v22, v86
  v_mul_f32 v23, v23, v87
  v_cvt_pk_bf16_f32 v33, v22, v23
  v_lshlrev_b32 v22, 16, v214
  v_and_b32 v23, 0xffff0000, v214
  v_mul_f32 v22, v22, v88
  v_mul_f32 v23, v23, v89
  v_cvt_pk_bf16_f32 v34, v22, v23
  v_lshlrev_b32 v22, 16, v215
  v_and_b32 v23, 0xffff0000, v215
  v_mul_f32 v22, v22, v90
  v_mul_f32 v23, v23, v91
  v_cvt_pk_bf16_f32 v35, v22, v23
  buffer_store_dwordx4 v[32:35], v6, s[28:31], s54 offen sc1
  v_mfma_f32_16x16x32_bf16 v[16:19], v[212:215], v[92:95], v[16:19]
  v_mfma_f32_16x16x32_bf16 v[12:15], v[32:35], v[8:11], v[12:15]
  s_add_u32 s54, s54, 8192
B_PD:
  v_lshrrev_b32 v20, 4, v2
  v_lshlrev_b32 v20, 4, v20
  s_lshl_b32 s37, s46, 7
  s_add_u32 s37, s37, 130944
  v_add_u32 v20, s37, v20
  v_cmp_eq_u32 vcc, 0, v7
  s_nop 0
  s_and_saveexec_b64 s[38:39], vcc
  ds_write_b128 v20, v[12:15]
  ds_write_b128 v20, v[16:19] offset:64
  s_mov_b64 exec, 1
  v_mov_b32 v21, 159760
  v_mov_b32 v22, 1
  s_waitcnt lgkmcnt(0)
  ds_add_rtn_u32 v23, v21, v22
  s_waitcnt lgkmcnt(0)
  v_readfirstlane_b32 s37, v23
  s_mov_b64 exec, -1
  s_cmp_lg_u32 s37, 3
  s_cbranch_scc1 B_PE
  v_lshlrev_b32 v20, 2, v2
  v_add_u32 v21, 130944, v20
  ds_read_b32 v22, v21
  ds_read_b32 v23, v21 offset:128
  ds_read_b32 v36, v21 offset:256
  ds_read_b32 v37, v21 offset:384
  v_lshrrev_b32 v38, 4, v2
  v_and_b32 v20, 15, v2
  v_lshl_add_u32 v20, v38, 5, v20
  v_lshlrev_b32 v20, 3, v20
  s_lshl_b32 s37, s59, 9
  s_lshl_b32 s38, s58, 7
  s_add_u32 s37, s37, s38
  s_add_u32 s37, s37, 262144
  s_waitcnt lgkmcnt(0)
  v_add_f32 v22, v22, v23
  v_add_f32 v36, v36, v37
  v_add_f32 v22, v22, v36
  v_cvt_pk_bf16_f32 v23, v22, v22
  v_and_b32 v23, 0xffff0000, v23
  v_sub_f32 v36, v22, v23
  v_cvt_pk_bf16_f32 v37, v36, v36
  v_and_b32 v37, 0xffff0000, v37
  v_sub_f32 v36, v36, v37
  v_cvt_pk_bf16_f32 v40, v23, v37
  v_cvt_pk_bf16_f32 v41, v36, 0
  s_mov_b32 exec_hi, 0
  buffer_store_dwordx2 v[40:41], v20, s[28:31], s37 offen sc1
  s_mov_b64 exec, -1
B_PE:
  v_mov_b32 v104, 159768
  s_mov_b32 s38, 0
LS_21:
  ds_read_b32 v105, v104
  s_waitcnt lgkmcnt(0)
  v_readfirstlane_b32 s37, v105
  s_nop 0
  s_cmp_ge_u32 s37, 4
  s_cbranch_scc1 LS_21D
  s_sleep 1
  s_add_u32 s38, s38, 1
  s_cmp_lt_u32 s38, 960000
  s_cbranch_scc1 LS_21
LS_21D:
  s_setprio 3
  s_and_b32 s37, s3, 1
  s_lshl_b32 s37, s37, 6
  v_add_u32 v104, s37, v2
  v_lshlrev_b32 v104, 1, v104
  v_bfe_u32 v105, v104, 3, 3
  v_xor_b32 v104, v104, v105
  v_xor_b32 v105, 1, v104
  s_lshl_b32 s37, s66, 13
  s_add_u32 s37, s37, 75776
  v_lshl_add_u32 v104, v104, 4, s37
  v_lshl_add_u32 v105, v105, 4, s37
  ds_read_b128 v[108:111], v104
  ds_read_b128 v[116:119], v104 offset:4096
  ds_read_b128 v[112:115], v105
  ds_read_b128 v[120:123], v105 offset:4096
  s_lshl_b32 s37, s67, 6
  s_add_u32 s37, s37, 1048576
  s_waitcnt lgkmcnt(2)
  v_add_f32 v108, v108, v116
  v_add_f32 v109, v109, v117
  v_mul_f32 v108, v108, v141
  v_mul_f32 v109, v109, v141
  v_cvt_pk_bf16_f32 v126, v108, v109
  v_lshlrev_b32 v124, 16, v126
  v_and_b32 v125, 0xffff0000, v126
  v_lshlrev_b32 v127, 16, v136
  v_and_b32 v128, 0xffff0000, v136
  v_add_f32 v124, v124, v127
  v_add_f32 v125, v125, v128
  v_cvt_pk_bf16_f32 v126, v124, v125
  v_lshlrev_b32 v124, 16, v126
  v_and_b32 v125, 0xffff0000, v126
  v_mul_f32 v124, v124, v142
  v_mul_f32 v125, v125, v142
  v_cvt_pk_bf16_f32 v126, v124, v125
  v_lshlrev_b32 v124, 16, v126
  v_and_b32 v125, 0xffff0000, v126
  v_lshlrev_b32 v127, 16, v132
  v_and_b32 v128, 0xffff0000, v132
  v_add_f32 v124, v124, v127
  v_add_f32 v125, v125, v128
  v_cvt_pk_bf16_f32 v136, v124, v125
  v_add_f32 v110, v110, v118
  v_add_f32 v111, v111, v119
  v_mul_f32 v110, v110, v141
  v_mul_f32 v111, v111, v141
  v_cvt_pk_bf16_f32 v102, v110, v111
  v_lshlrev_b32 v100, 16, v102
  v_and_b32 v101, 0xffff0000, v102
  v_lshlrev_b32 v130, 16, v137
  v_and_b32 v131, 0xffff0000, v137
  v_add_f32 v100, v100, v130
  v_add_f32 v101, v101, v131
  v_cvt_pk_bf16_f32 v102, v100, v101
  v_lshlrev_b32 v100, 16, v102
  v_and_b32 v101, 0xffff0000, v102
  v_mul_f32 v100, v100, v142
  v_mul_f32 v101, v101, v142
  v_cvt_pk_bf16_f32 v102, v100, v101
  v_lshlrev_b32 v100, 16, v102
  v_and_b32 v101, 0xffff0000, v102
  v_lshlrev_b32 v130, 16, v133
  v_and_b32 v131, 0xffff0000, v133
  v_add_f32 v100, v100, v130
  v_add_f32 v101, v101, v131
  v_cvt_pk_bf16_f32 v137, v100, v101
  s_waitcnt lgkmcnt(0)
  s_waitcnt lgkmcnt(0)
  s_mov_b64 exec, 1
  v_mov_b32 v104, 159780
  v_mov_b32 v105, 1
  ds_add_u32 v104, v105
  s_mov_b64 exec, -1
  v_add_f32 v112, v112, v120
  v_add_f32 v113, v113, v121
  v_mul_f32 v112, v112, v141
  v_mul_f32 v113, v113, v141
  v_cvt_pk_bf16_f32 v126, v112, v113
  v_lshlrev_b32 v124, 16, v126
  v_and_b32 v125, 0xffff0000, v126
  v_lshlrev_b32 v127, 16, v138
  v_and_b32 v128, 0xffff0000, v138
  v_add_f32 v124, v124, v127
  v_add_f32 v125, v125, v128
  v_cvt_pk_bf16_f32 v126, v124, v125
  v_lshlrev_b32 v124, 16, v126
  v_and_b32 v125, 0xffff0000, v126
  v_mul_f32 v124, v124, v142
  v_mul_f32 v125, v125, v142
  v_cvt_pk_bf16_f32 v126, v124, v125
  v_lshlrev_b32 v124, 16, v126
  v_and_b32 v125, 0xffff0000, v126
  v_lshlrev_b32 v127, 16, v134
  v_and_b32 v128, 0xffff0000, v134
  v_add_f32 v124, v124, v127
  v_add_f32 v125, v125, v128
  v_cvt_pk_bf16_f32 v138, v124, v125
  v_add_f32 v114, v114, v122
  v_add_f32 v115, v115, v123
  v_mul_f32 v114, v114, v141
  v_mul_f32 v115, v115, v141
  v_cvt_pk_bf16_f32 v102, v114, v115
  v_lshlrev_b32 v100, 16, v102
  v_and_b32 v101, 0xffff0000, v102
  v_lshlrev_b32 v130, 16, v139
  v_and_b32 v131, 0xffff0000, v139
  v_add_f32 v100, v100, v130
  v_add_f32 v101, v101, v131
  v_cvt_pk_bf16_f32 v102, v100, v101
  v_lshlrev_b32 v100, 16, v102
  v_and_b32 v101, 0xffff0000, v102
  v_mul_f32 v100, v100, v142
  v_mul_f32 v101, v101, v142
  v_cvt_pk_bf16_f32 v102, v100, v101
  v_lshlrev_b32 v100, 16, v102
  v_and_b32 v101, 0xffff0000, v102
  v_lshlrev_b32 v130, 16, v135
  v_and_b32 v131, 0xffff0000, v135
  v_add_f32 v100, v100, v130
  v_add_f32 v101, v101, v131
  v_cvt_pk_bf16_f32 v139, v100, v101
  buffer_store_dwordx4 v[136:139], v140, s[28:31], s37 offen sc1
  s_waitcnt vmcnt(1)
  s_mov_b64 exec, 1
  v_mov_b32 v20, 159764
  v_mov_b32 v21, 1
  ds_add_rtn_u32 v22, v20, v21
  s_waitcnt lgkmcnt(0)
  v_readfirstlane_b32 s37, v22
  s_nop 0
  s_cmp_lg_u32 s37, 3
  s_cbranch_scc1 ARR_22
  s_lshl_b32 s37, s2, 6
  s_add_u32 s37, s37, 147456
  v_mov_b32 v20, 0
  v_mov_b32 v21, 1
  buffer_store_dword v21, v20, s[28:31], s37 offen sc1
ARR_22:
  s_mov_b64 exec, -1
  s_waitcnt vmcnt(0)
  s_mov_b64 exec, 1
  v_mov_b32 v20, 159748
  v_mov_b32 v21, 1
  ds_add_rtn_u32 v22, v20, v21
  s_waitcnt lgkmcnt(0)
  v_readfirstlane_b32 s37, v22
  s_nop 0
  s_cmp_lg_u32 s37, 3
  s_cbranch_scc1 ARR_23
  s_lshl_b32 s37, s2, 6
  s_add_u32 s37, s37, 163840
  v_mov_b32 v20, 0
  v_mov_b32 v21, 1
  buffer_store_dword v21, v20, s[28:31], s37 offen sc1
ARR_23:
  s_mov_b64 exec, -1
  s_setprio 0
  s_branch C_ENTRY
T_ENTRY:
  s_sub_u32 s44, s2, 224
  s_cmp_lg_u32 s3, 1
  s_cbranch_scc1 T_NOZ
  v_lshlrev_b32 v9, 14, v2
  s_lshl_b32 s37, s2, 6
  s_add_u32 s37, s37, 147456
  s_mov_b64 exec, 31
  buffer_store_dword v24, v9, s[28:31], s37 offen sc1
  s_mov_b64 exec, -1
T_NOZ:
  s_cmp_lg_u32 s2, 255
  s_cbranch_scc1 T_NOG
  s_cmp_lg_u32 s3, 2
  s_cbranch_scc1 T_NOG
  v_lshlrev_b32 v9, 6, v2
  s_mov_b32 s37, 131072
  buffer_store_dword v24, v9, s[28:31], s37 offen sc1
  s_mov_b32 s37, 135168
  buffer_store_dword v24, v9, s[28:31], s37 offen sc1
  s_mov_b32 s37, 139264
  buffer_store_dword v24, v9, s[28:31], s37 offen sc1
  s_mov_b32 s37, 143360
  buffer_store_dword v24, v9, s[28:31], s37 offen sc1
  s_waitcnt vmcnt(0)
  v_mov_b32 v9, 1
  s_mov_b64 exec, 1
  buffer_store_dword v9, v24, s[32:35], 0 offen sc1
  s_mov_b64 exec, -1
T_NOG:
  s_waitcnt vmcnt(0)
  s_mov_b32 s38, 0x3f803f80
  v_mov_b32 v48, 0
  v_mov_b32 v49, 0
  v_dot2_f32_bf16 v48, v184, s38, v48
  v_dot2_f32_bf16 v48, v185, s38, v48
  v_dot2_f32_bf16 v48, v186, s38, v48
  v_dot2_f32_bf16 v48, v187, s38, v48
  v_dot2_f32_bf16 v49, v184, v184, v49
  v_dot2_f32_bf16 v49, v185, v185, v49
  v_dot2_f32_bf16 v49, v186, v186, v49
  v_dot2_f32_bf16 v49, v187, v187, v49
  v_add_f32_dpp v48, v48, v48 row_shr:1 row_mask:0xf bank_mask:0xf bound_ctrl:0
  s_nop 1
  v_add_f32_dpp v49, v49, v49 row_shr:1 row_mask:0xf bank_mask:0xf bound_ctrl:0
  v_add_f32_dpp v48, v48, v48 row_shr:2 row_mask:0xf bank_mask:0xf bound_ctrl:0
  s_nop 0
  v_add_f32_dpp v49, v49, v49 row_shr:2 row_mask:0xf bank_mask:0xf bound_ctrl:0
  v_add_f32_dpp v48, v48, v48 row_shr:4 row_mask:0xf bank_mask:0xf bound_ctrl:0
  s_nop 0
  v_add_f32_dpp v49, v49, v49 row_shr:4 row_mask:0xf bank_mask:0xf bound_ctrl:0
  v_add_f32_dpp v48, v48, v48 row_shr:8 row_mask:0xf bank_mask:0xf bound_ctrl:0
  s_nop 0
  v_add_f32_dpp v49, v49, v49 row_shr:8 row_mask:0xf bank_mask:0xf bound_ctrl:0
  v_add_f32_dpp v48, v48, v48 row_bcast:15 row_mask:0xa bank_mask:0xf
  s_nop 0
  v_add_f32_dpp v49, v49, v49 row_bcast:15 row_mask:0xa bank_mask:0xf
  v_add_f32_dpp v48, v48, v48 row_bcast:31 row_mask:0xc bank_mask:0xf
  s_nop 0
  v_add_f32_dpp v49, v49, v49 row_bcast:31 row_mask:0xc bank_mask:0xf
  v_mul_f32 v48, 0x3b124925, v48
  v_mul_f32 v49, 0x3b124925, v49
  v_fma_f32 v49, -v48, v48, v49
  v_max_f32 v49, 0, v49
  v_cvt_pk_bf16_f32 v48, v48, v48
  v_and_b32 v48, 0xffff0000, v48
  v_cvt_pk_bf16_f32 v49, v49, v49
  v_and_b32 v49, 0xffff0000, v49
  v_add_f32 v49, 0x3727c5ac, v49
  v_cvt_pk_bf16_f32 v49, v49, v49
  v_and_b32 v49, 0xffff0000, v49
  v_sqrt_f32 v49, v49
  s_nop 0
  v_cvt_pk_bf16_f32 v49, v49, v49
  v_and_b32 v49, 0xffff0000, v49
  v_rcp_f32 v49, v49
  v_readlane_b32 s38, v48, 63
  v_readlane_b32 s39, v49, 63
  s_mul_i32 s37, s3, 912
  s_add_u32 s37, s37, 111936
  v_lshl_add_u32 v50, v2, 4, s37
  v_lshlrev_b32 v52, 16, v184
  v_and_b32 v53, 0xffff0000, v184
  v_subrev_f32 v52, s38, v52
  v_subrev_f32 v53, s38, v53
  v_cvt_pk_bf16_f32 v54, v52, v53
  v_lshlrev_b32 v52, 16, v54
  v_and_b32 v53, 0xffff0000, v54
  v_mul_f32 v52, s39, v52
  v_mul_f32 v53, s39, v53
  v_cvt_pk_bf16_f32 v56, v52, v53
  v_lshlrev_b32 v52, 16, v185
  v_and_b32 v53, 0xffff0000, v185
  v_subrev_f32 v52, s38, v52
  v_subrev_f32 v53, s38, v53
  v_cvt_pk_bf16_f32 v54, v52, v53
  v_lshlrev_b32 v52, 16, v54
  v_and_b32 v53, 0xffff0000, v54
  v_mul_f32 v52, s39, v52
  v_mul_f32 v53, s39, v53
  v_cvt_pk_bf16_f32 v57, v52, v53
  v_lshlrev_b32 v52, 16, v186
  v_and_b32 v53, 0xffff0000, v186
  v_subrev_f32 v52, s38, v52
  v_subrev_f32 v53, s38, v53
  v_cvt_pk_bf16_f32 v54, v52, v53
  v_lshlrev_b32 v52, 16, v54
  v_and_b32 v53, 0xffff0000, v54
  v_mul_f32 v52, s39, v52
  v_mul_f32 v53, s39, v53
  v_cvt_pk_bf16_f32 v58, v52, v53
  v_lshlrev_b32 v52, 16, v187
  v_and_b32 v53, 0xffff0000, v187
  v_subrev_f32 v52, s38, v52
  v_subrev_f32 v53, s38, v53
  v_cvt_pk_bf16_f32 v54, v52, v53
  v_lshlrev_b32 v52, 16, v54
  v_and_b32 v53, 0xffff0000, v54
  v_mul_f32 v52, s39, v52
  v_mul_f32 v53, s39, v53
  v_cvt_pk_bf16_f32 v59, v52, v53
  v_cmp_gt_u32 vcc, 56, v2
  s_nop 0
  s_and_saveexec_b64 s[38:39], vcc
  ds_write_b128 v50, v[184:187]
  ds_write_b128 v50, v[56:59] offset:7296
  s_mov_b64 exec, -1
  v_bfe_u32 v51, v2, 2, 2
  v_mul_u32_u24 v51, 912, v51
  v_bfe_u32 v52, v2, 4, 1
  v_mul_u32_u24 v52, 7296, v52
  v_add_u32 v51, v51, v52
  v_lshrrev_b32 v52, 5, v2
  v_lshl_add_u32 v51, v52, 5, v51
  v_and_b32 v53, 3, v2
  v_lshl_add_u32 v51, v53, 3, v51
  s_lshl_b32 s37, s3, 6
  s_add_u32 s37, s37, 111936
  v_add_u32 v51, s37, v51
  v_and_b32 v53, 15, v2
  v_lshl_add_u32 v53, v52, 4, v53
  v_lshlrev_b32 v53, 5, v53
  v_bfe_u32 v52, v2, 4, 1
  v_lshl_add_u32 v53, v52, 4, v53
  s_mul_i32 s37, s2, 14336
  s_lshl_b32 s38, s3, 10
  s_add_u32 s37, s37, s38
  s_add_u32 s37, s37, 12582912
  s_add_u32 s38, s37, 8192
  s_waitcnt lgkmcnt(0)
  s_barrier
  ds_read_b64_tr_b16 v[56:57], v51
  ds_read_b64_tr_b16 v[58:59], v51 offset:3648
  ds_read_b64_tr_b16 v[60:61], v51 offset:512
  ds_read_b64_tr_b16 v[62:63], v51 offset:4160
  s_waitcnt lgkmcnt(2)
  buffer_store_dwordx4 v[56:59], v53, s[28:31], s37 offen sc1
  s_waitcnt lgkmcnt(0)
  s_cmp_ge_u32 s3, 6
  s_cbranch_scc1 LN2_24
  buffer_store_dwordx4 v[60:63], v53, s[28:31], s38 offen sc1
LN2_24:
  buffer_load_dword v195, v24, s[32:35], 0 offen sc1
  s_waitcnt vmcnt(0)
  s_mov_b64 exec, 1
  v_mov_b32 v100, 159744
  v_mov_b32 v101, 1
  ds_add_rtn_u32 v102, v100, v101
  s_waitcnt lgkmcnt(0)
  v_readfirstlane_b32 s37, v102
  s_nop 0
  s_cmp_lg_u32 s37, 7
  s_cbranch_scc1 ARR_25
  s_mov_b32 s38, 0
  v_mov_b32 v100, 0
  v_readfirstlane_b32 s37, v195
  s_nop 0
  s_cmp_lg_u32 s37, 0
  s_cbranch_scc1 GO_26D
GO_26:
  buffer_load_dword v102, v100, s[32:35], 0 offen sc1
  s_waitcnt vmcnt(0)
  v_readfirstlane_b32 s37, v102
  s_add_u32 s38, s38, 1
  s_cmp_ge_u32 s38, 60000
  s_cbranch_scc1 GO_26D
  s_cmp_eq_u32 s37, 0
  s_cbranch_scc1 GO_26
GO_26D:
  s_lshl_b32 s37, s2, 6
  s_add_u32 s37, s37, 131072
  v_mov_b32 v100, 0
  v_mov_b32 v101, 1
  buffer_store_dword v101, v100, s[28:31], s37 offen sc1
ARR_25:
  s_mov_b64 exec, -1
  s_barrier
  s_lshl_b32 s47, s3, 5
  s_add_u32 s47, s47, s44
  s_mov_b32 s50, 0
  s_cmp_ge_u32 s47, 112
  s_cbranch_scc1 T_NOW2
  s_mov_b32 s50, 1
  s_mov_b32 s40, s24
  s_and_b32 s41, s25, 0xffff
  s_mov_b32 s42, 1605632
  s_mov_b32 s43, 0x20000
  s_mul_i32 s48, s47, 14336
  s_mul_i32 s49, s3, 14336
  s_add_u32 s49, s49, 0
  s_add_u32 m0, s49, 0
  s_add_u32 s37, s48, 0
  buffer_load_dwordx4 v3, s[40:43], s37 offen lds
  s_add_u32 m0, s49, 1024
  s_add_u32 s37, s48, 1024
  buffer_load_dwordx4 v3, s[40:43], s37 offen lds
  s_add_u32 m0, s49, 2048
  s_add_u32 s37, s48, 2048
  buffer_load_dwordx4 v3, s[40:43], s37 offen lds
  s_add_u32 m0, s49, 3072
  s_add_u32 s37, s48, 3072
  buffer_load_dwordx4 v3, s[40:43], s37 offen lds
  s_add_u32 m0, s49, 4096
  s_add_u32 s37, s48, 4096
  buffer_load_dwordx4 v3, s[40:43], s37 offen lds
  s_add_u32 m0, s49, 5120
  s_add_u32 s37, s48, 5120
  buffer_load_dwordx4 v3, s[40:43], s37 offen lds
  s_add_u32 m0, s49, 6144
  s_add_u32 s37, s48, 6144
  buffer_load_dwordx4 v3, s[40:43], s37 offen lds
  s_add_u32 m0, s49, 7168
  s_add_u32 s37, s48, 7168
  buffer_load_dwordx4 v3, s[40:43], s37 offen lds
  s_add_u32 m0, s49, 8192
  s_add_u32 s37, s48, 8192
  buffer_load_dwordx4 v3, s[40:43], s37 offen lds
  s_add_u32 m0, s49, 9216
  s_add_u32 s37, s48, 9216
  buffer_load_dwordx4 v3, s[40:43], s37 offen lds
  s_add_u32 m0, s49, 10240
  s_add_u32 s37, s48, 10240
  buffer_load_dwordx4 v3, s[40:43], s37 offen lds
  s_add_u32 m0, s49, 11264
  s_add_u32 s37, s48, 11264
  buffer_load_dwordx4 v3, s[40:43], s37 offen lds
  s_add_u32 m0, s49, 12288
  s_add_u32 s37, s48, 12288
  buffer_load_dwordx4 v3, s[40:43], s37 offen lds
  s_add_u32 m0, s49, 13312
  s_add_u32 s37, s48, 13312
  buffer_load_dwordx4 v3, s[40:43], s37 offen lds
T_NOW2:
  s_cmp_eq_u32 s50, 0
  s_cbranch_scc1 T_W2D
  v_lshrrev_b32 v4, 5, v2
  v_bfe_u32 v5, v2, 2, 2
  v_lshl_add_u32 v4, v4, 2, v5
  s_movk_i32 s37, 896
  v_mul_lo_u32 v4, v4, s37
  v_bfe_u32 v5, v2, 4, 1
  v_lshl_add_u32 v4, v5, 5, v4
  v_and_b32 v5, 3, v2
  v_lshl_add_u32 v4, v5, 3, v4
  v_add_u32 v4, s49, v4
  s_lshl_b32 s53, s47, 10
  s_add_u32 s53, s53, 8388608
  s_waitcnt vmcnt(0)
  ds_read_b64_tr_b16 v[56:57], v4 offset:0
  ds_read_b64_tr_b16 v[58:59], v4 offset:7168
  ds_read_b64_tr_b16 v[60:61], v4 offset:64
  ds_read_b64_tr_b16 v[62:63], v4 offset:7232
  ds_read_b64_tr_b16 v[64:65], v4 offset:128
  ds_read_b64_tr_b16 v[66:67], v4 offset:7296
  ds_read_b64_tr_b16 v[68:69], v4 offset:192
  ds_read_b64_tr_b16 v[70:71], v4 offset:7360
  ds_read_b64_tr_b16 v[72:73], v4 offset:256
  ds_read_b64_tr_b16 v[74:75], v4 offset:7424
  ds_read_b64_tr_b16 v[76:77], v4 offset:320
  ds_read_b64_tr_b16 v[78:79], v4 offset:7488
  ds_read_b64_tr_b16 v[80:81], v4 offset:384
  ds_read_b64_tr_b16 v[82:83], v4 offset:7552
  ds_read_b64_tr_b16 v[84:85], v4 offset:448
  ds_read_b64_tr_b16 v[86:87], v4 offset:7616
  ds_read_b64_tr_b16 v[88:89], v4 offset:512
  ds_read_b64_tr_b16 v[90:91], v4 offset:7680
  ds_read_b64_tr_b16 v[92:93], v4 offset:576
  ds_read_b64_tr_b16 v[94:95], v4 offset:7744
  ds_read_b64_tr_b16 v[96:97], v4 offset:640
  ds_read_b64_tr_b16 v[98:99], v4 offset:7808
  ds_read_b64_tr_b16 v[100:101], v4 offset:704
  ds_read_b64_tr_b16 v[102:103], v4 offset:7872
  ds_read_b64_tr_b16 v[104:105], v4 offset:768
  ds_read_b64_tr_b16 v[106:107], v4 offset:7936
  ds_read_b64_tr_b16 v[108:109], v4 offset:832
  ds_read_b64_tr_b16 v[110:111], v4 offset:8000
  s_waitcnt lgkmcnt(15)
  buffer_store_dwordx4 v[56:59], v3, s[28:31], s53 offen sc1
  s_add_u32 s53, s53, 114688
  s_waitcnt lgkmcnt(15)
  buffer_store_dwordx4 v[60:63], v3, s[28:31], s53 offen sc1
  s_add_u32 s53, s53, 114688
  s_waitcnt lgkmcnt(15)
  buffer_store_dwordx4 v[64:67], v3, s[28:31], s53 offen sc1
  s_add_u32 s53, s53, 114688
  s_waitcnt lgkmcnt(15)
  buffer_store_dwordx4 v[68:71], v3, s[28:31], s53 offen sc1
  s_add_u32 s53, s53, 114688
  s_waitcnt lgkmcnt(15)
  buffer_store_dwordx4 v[72:75], v3, s[28:31], s53 offen sc1
  s_add_u32 s53, s53, 114688
  s_waitcnt lgkmcnt(15)
  buffer_store_dwordx4 v[76:79], v3, s[28:31], s53 offen sc1
  s_add_u32 s53, s53, 114688
  s_waitcnt lgkmcnt(14)
  buffer_store_dwordx4 v[80:83], v3, s[28:31], s53 offen sc1
  s_add_u32 s53, s53, 114688
  s_waitcnt lgkmcnt(12)
  buffer_store_dwordx4 v[84:87], v3, s[28:31], s53 offen sc1
  s_add_u32 s53, s53, 114688
  s_waitcnt lgkmcnt(10)
  buffer_store_dwordx4 v[88:91], v3, s[28:31], s53 offen sc1
  s_add_u32 s53, s53, 114688
  s_waitcnt lgkmcnt(8)
  buffer_store_dwordx4 v[92:95], v3, s[28:31], s53 offen sc1
  s_add_u32 s53, s53, 114688
  s_waitcnt lgkmcnt(6)
  buffer_store_dwordx4 v[96:99], v3, s[28:31], s53 offen sc1
  s_add_u32 s53, s53, 114688
  s_waitcnt lgkmcnt(4)
  buffer_store_dwordx4 v[100:103], v3, s[28:31], s53 offen sc1
  s_add_u32 s53, s53, 114688
  s_waitcnt lgkmcnt(2)
  buffer_store_dwordx4 v[104:107], v3, s[28:31], s53 offen sc1
  s_add_u32 s53, s53, 114688
  s_waitcnt lgkmcnt(0)
  buffer_store_dwordx4 v[108:111], v3, s[28:31], s53 offen sc1
  s_add_u32 s53, s53, 114688
T_W2D:
  s_waitcnt vmcnt(0)
  s_mov_b64 exec, 1
  v_mov_b32 v100, 159748
  v_mov_b32 v101, 1
  ds_add_rtn_u32 v102, v100, v101
  s_waitcnt lgkmcnt(0)
  v_readfirstlane_b32 s37, v102
  s_nop 0
  s_cmp_lg_u32 s37, 7
  s_cbranch_scc1 ARR_27
  s_lshl_b32 s37, s2, 6
  s_add_u32 s37, s37, 163840
  v_mov_b32 v100, 0
  v_mov_b32 v101, 1
  buffer_store_dword v101, v100, s[28:31], s37 offen sc1
ARR_27:
  s_mov_b64 exec, -1
  s_mov_b64 exec, 1
  v_mov_b32 v100, 159756
  v_mov_b32 v101, 1
  ds_add_rtn_u32 v102, v100, v101
  s_waitcnt lgkmcnt(0)
  v_readfirstlane_b32 s37, v102
  s_nop 0
  s_cmp_lg_u32 s37, 7
  s_cbranch_scc1 ARR_28
  s_lshl_b32 s37, s2, 6
  s_add_u32 s37, s37, 180224
  v_mov_b32 v100, 0
  v_mov_b32 v101, 1
  buffer_store_dword v101, v100, s[28:31], s37 offen sc1
ARR_28:
  s_mov_b64 exec, -1
  s_cmp_lg_u32 s3, 0
  s_cbranch_scc1 T_W
  v_lshlrev_b32 v104, 6, v2
  s_mov_b32 s38, 0
  s_mov_b64 s[40:41], -1
  s_mov_b64 s[42:43], -1
  s_mov_b64 s[76:77], -1
  s_mov_b64 s[78:79], -1
PA_29:
  s_mov_b64 exec, s[40:41]
  s_cbranch_execz PA_29_0
  s_mov_b32 s39, 131072
  buffer_load_dword v105, v104, s[28:31], s39 offen sc1
PA_29_0:
  s_mov_b64 exec, s[42:43]
  s_cbranch_execz PA_29_1
  s_mov_b32 s39, 135168
  buffer_load_dword v106, v104, s[28:31], s39 offen sc1
PA_29_1:
  s_mov_b64 exec, s[76:77]
  s_cbranch_execz PA_29_2
  s_mov_b32 s39, 139264
  buffer_load_dword v107, v104, s[28:31], s39 offen sc1
PA_29_2:
  s_mov_b64 exec, s[78:79]
  s_cbranch_execz PA_29_3
  s_mov_b32 s39, 143360
  buffer_load_dword v108, v104, s[28:31], s39 offen sc1
PA_29_3:
  s_mov_b64 exec, -1
  s_waitcnt vmcnt(0)
  v_cmp_ne_u32 vcc, 1, v105
  s_nop 0
  s_and_b64 s[40:41], s[40:41], vcc
  v_cmp_ne_u32 vcc, 1, v106
  s_nop 0
  s_and_b64 s[42:43], s[42:43], vcc
  v_cmp_ne_u32 vcc, 1, v107
  s_nop 0
  s_and_b64 s[76:77], s[76:77], vcc
  v_cmp_ne_u32 vcc, 1, v108
  s_nop 0
  s_and_b64 s[78:79], s[78:79], vcc
  s_or_b64 vcc, s[40:41], s[42:43]
  s_or_b64 vcc, vcc, s[76:77]
  s_or_b64 vcc, vcc, s[78:79]
  s_cbranch_scc0 PA_29D
  s_sleep 4
  s_add_u32 s38, s38, 1
  s_cmp_lt_u32 s38, 60000
  s_cbranch_scc1 PA_29
PA_29D:
T_W:
  s_barrier
  s_and_b32 s4, s2, 7
  s_lshr_b32 s5, s2, 3
  s_lshr_b32 s6, s4, 2
  s_lshl_b32 s6, s6, 3
  s_and_b32 s37, s5, 7
  s_add_u32 s6, s6, s37
  s_and_b32 s7, s4, 3
  s_lshl_b32 s7, s7, 2
  s_lshr_b32 s37, s5, 3
  s_add_u32 s7, s7, s37
  s_mul_i32 s8, s7, 7
  s_add_u32 s8, s8, s3
  s_lshl_b32 s20, s4, 2
  s_and_b32 s37, s5, 3
  s_add_u32 s20, s20, s37
  s_lshr_b32 s21, s5, 2
  s_lshl_b32 s37, s37, 1
  s_add_u32 s22, s37, s21
  s_add_u32 s22, s22, s3
  s_and_b32 s22, s22, 7
  s_mul_i32 s23, s22, 14336
  s_mul_i32 s24, s21, 229376
  s_add_u32 s24, s24, s23
  s_add_u32 s24, s24, 8388608
  s_cmp_ge_u32 s2, 224
  s_cselect_b32 s24, 8388608, s24
  s_mul_i32 s12, s8, 28672
  s_add_u32 s12, s12, 4194304
  v_lshlrev_b32 v106, 4, v2
  v_and_b32 v104, 1, v2
  s_min_u32 s37, s8, 111
  s_lshl_b32 s37, s37, 1
  v_add_u32 v104, s37, v104
  s_mov_b32 s37, 153391690
  v_mul_hi_u32 v105, v104, s37
  v_mul_u32_u24 v107, 28, v105
  v_sub_u32 v107, v104, v107
  v_lshl_add_u32 v107, v107, 3, v105
  v_lshlrev_b32 v107, 6, v107
  s_mov_b32 s19, 0
C_ENTRY:
  v_lshlrev_b32 v12, 4, v2
  v_lshrrev_b32 v5, 5, v2
  s_cmp_eq_u32 s3, 7
  s_cbranch_scc1 C_STATS
  s_cmp_lg_u32 s19, 0
  s_cbranch_scc1 C_HAVEW
  s_mov_b32 s38, 0
  s_mov_b32 s40, 147456
  s_mov_b64 exec, 3
P2_30:
  buffer_load_dword v9, v107, s[28:31], s40 offen sc1
  s_waitcnt vmcnt(0)
  v_cmp_gt_u32 vcc, 1, v9
  s_nop 0
  s_cmp_eq_u64 vcc, 0
  s_cbranch_scc1 P2_30D
  s_sleep 4
  s_add_u32 s38, s38, 1
  s_cmp_lt_u32 s38, 60000
  s_cbranch_scc1 P2_30
P2_30D:
  s_mov_b64 exec, -1
  s_add_u32 s37, s12, 0
  buffer_load_dwordx4 v[144:147], v106, s[28:31], s37 offen sc1
  s_add_u32 s37, s12, 1024
  buffer_load_dwordx4 v[148:151], v106, s[28:31], s37 offen sc1
  s_add_u32 s37, s12, 2048
  buffer_load_dwordx4 v[152:155], v106, s[28:31], s37 offen sc1
  s_add_u32 s37, s12, 3072
  buffer_load_dwordx4 v[156:159], v106, s[28:31], s37 offen sc1
  s_add_u32 s37, s12, 4096
  buffer_load_dwordx4 v[160:163], v106, s[28:31], s37 offen sc1
  s_add_u32 s37, s12, 5120
  buffer_load_dwordx4 v[164:167], v106, s[28:31], s37 offen sc1
  s_add_u32 s37, s12, 6144
  buffer_load_dwordx4 v[168:171], v106, s[28:31], s37 offen sc1
  s_add_u32 s37, s12, 7168
  buffer_load_dwordx4 v[172:175], v106, s[28:31], s37 offen sc1
  s_add_u32 s37, s12, 8192
  buffer_load_dwordx4 v[176:179], v106, s[28:31], s37 offen sc1
  s_add_u32 s37, s12, 9216
  buffer_load_dwordx4 v[180:183], v106, s[28:31], s37 offen sc1
  s_add_u32 s37, s12, 10240
  buffer_load_dwordx4 v[184:187], v106, s[28:31], s37 offen sc1
  s_add_u32 s37, s12, 11264
  buffer_load_dwordx4 v[188:191], v106, s[28:31], s37 offen sc1
  s_add_u32 s37, s12, 12288
  buffer_load_dwordx4 v[192:195], v106, s[28:31], s37 offen sc1
  s_add_u32 s37, s12, 13312
  buffer_load_dwordx4 v[196:199], v106, s[28:31], s37 offen sc1
  s_add_u32 s37, s12, 14336
  buffer_load_dwordx4 v[200:203], v106, s[28:31], s37 offen sc1
  s_add_u32 s37, s12, 15360
  buffer_load_dwordx4 v[204:207], v106, s[28:31], s37 offen sc1
  s_add_u32 s37, s12, 16384
  buffer_load_dwordx4 v[208:211], v106, s[28:31], s37 offen sc1
  s_add_u32 s37, s12, 17408
  buffer_load_dwordx4 v[212:215], v106, s[28:31], s37 offen sc1
  s_add_u32 s37, s12, 18432
  buffer_load_dwordx4 v[216:219], v106, s[28:31], s37 offen sc1
  s_add_u32 s37, s12, 19456
  buffer_load_dwordx4 v[220:223], v106, s[28:31], s37 offen sc1
  s_add_u32 s37, s12, 20480
  buffer_load_dwordx4 v[224:227], v106, s[28:31], s37 offen sc1
  s_add_u32 s37, s12, 21504
  buffer_load_dwordx4 v[228:231], v106, s[28:31], s37 offen sc1
  s_add_u32 s37, s12, 22528
  buffer_load_dwordx4 v[232:235], v106, s[28:31], s37 offen sc1
  s_add_u32 s37, s12, 23552
  buffer_load_dwordx4 v[236:239], v106, s[28:31], s37 offen sc1
  s_add_u32 s37, s12, 24576
  buffer_load_dwordx4 v[240:243], v106, s[28:31], s37 offen sc1
  s_add_u32 s37, s12, 25600
  buffer_load_dwordx4 v[244:247], v106, s[28:31], s37 offen sc1
  s_add_u32 s37, s12, 26624
  buffer_load_dwordx4 v[248:251], v106, s[28:31], s37 offen sc1
  s_add_u32 s37, s12, 27648
  buffer_load_dwordx4 v[252:255], v106, s[28:31], s37 offen sc1
C_HAVEW:
  s_cmp_ge_u32 s3, 4
  s_cbranch_scc1 C_NOFB
  s_cmp_ge_u32 s2, 224
  s_cbranch_scc1 C_NOFB
  s_cmp_eq_u32 s19, 0
  s_cbranch_scc1 C_FB2
  s_waitcnt vmcnt(0)
C_FB2:
  s_mov_b64 exec, 1
  v_mov_b32 v36, 159756
  v_mov_b32 v37, 1
  ds_add_rtn_u32 v38, v36, v37
  s_waitcnt lgkmcnt(0)
  v_readfirstlane_b32 s37, v38
  s_nop 0
  s_cmp_lg_u32 s37, 3
  s_cbranch_scc1 ARR_31
  s_lshl_b32 s37, s2, 6
  s_add_u32 s37, s37, 180224
  v_mov_b32 v36, 0
  v_mov_b32 v37, 1
  buffer_store_dword v37, v36, s[28:31], s37 offen sc1
ARR_31:
  s_mov_b64 exec, -1
C_NOFB:
  v_lshlrev_b32 v13, 3, v2
  s_lshl_b32 s13, s8, 9
  s_add_u32 s13, s13, 262144
  s_waitcnt vmcnt(28)
  buffer_load_dwordx2 v[16:17], v13, s[28:31], s13 offen sc1
  v_bfe_u32 v6, v2, 2, 2
  v_lshl_add_u32 v7, v5, 2, v6
  v_lshlrev_b32 v7, 6, v7
  v_bfe_u32 v8, v2, 4, 1
  v_lshl_add_u32 v7, v8, 5, v7
  v_and_b32 v8, 3, v2
  v_lshl_add_u32 v11, v8, 3, v7
  v_add_u32 v10, 102400, v11
  v_add_u32 v13, 159872, v13
  v_and_b32 v9, 31, v2
  v_lshlrev_b32 v9, 3, v9
  v_add_u32 v9, 160384, v9
  v_mov_b32 v18, 0
  v_mov_b32 v19, 0
  v_mov_b32 v22, 0
  v_mov_b32 v23, 0
  s_mul_i32 s14, s6, 229376
  s_lshl_b32 s15, s8, 10
  s_add_u32 s14, s14, s15
  s_add_u32 s14, s14, 16777216
  s_mul_i32 s16, s3, 6144
  s_add_u32 s16, s16, 57344
  s_lshl_b32 s18, s3, 13
  s_add_u32 s18, s18, 102400
  s_lshl_b32 s10, s3, 10
  s_mul_i32 s9, s6, 57344
  s_add_u32 s9, s9, 1048576
  s_add_u32 s9, s9, s10
  v_mov_b32 v48, 0
  v_mov_b32 v49, 0
  v_mov_b32 v50, 0
  v_mov_b32 v51, 0
  v_mov_b32 v52, 0
  v_mov_b32 v53, 0
  v_mov_b32 v54, 0
  v_mov_b32 v55, 0
  v_mov_b32 v56, 0
  v_mov_b32 v57, 0
  v_mov_b32 v58, 0
  v_mov_b32 v59, 0
  v_mov_b32 v60, 0
  v_mov_b32 v61, 0
  v_mov_b32 v62, 0
  v_mov_b32 v63, 0
  v_mov_b32 v64, 0
  v_mov_b32 v65, 0
  v_mov_b32 v66, 0
  v_mov_b32 v67, 0
  v_mov_b32 v68, 0
  v_mov_b32 v69, 0
  v_mov_b32 v70, 0
  v_mov_b32 v71, 0
  v_mov_b32 v72, 0
  v_mov_b32 v73, 0
  v_mov_b32 v74, 0
  v_mov_b32 v75, 0
  v_mov_b32 v76, 0
  v_mov_b32 v77, 0
  v_mov_b32 v78, 0
  v_mov_b32 v79, 0
  v_mov_b32 v80, 0
  v_mov_b32 v81, 0
  v_mov_b32 v82, 0
  v_mov_b32 v83, 0
  v_mov_b32 v84, 0
  v_mov_b32 v85, 0
  v_mov_b32 v86, 0
  v_mov_b32 v87, 0
  v_mov_b32 v88, 0
  v_mov_b32 v89, 0
  v_mov_b32 v90, 0
  v_mov_b32 v91, 0
  v_mov_b32 v92, 0
  v_mov_b32 v93, 0
  v_mov_b32 v94, 0
  v_mov_b32 v95, 0
  v_mov_b32 v96, 0
  v_mov_b32 v97, 0
  v_mov_b32 v98, 0
  v_mov_b32 v99, 0
  v_mov_b32 v100, 0
  v_mov_b32 v101, 0
  v_mov_b32 v102, 0
  v_mov_b32 v103, 0
  v_mov_b32 v104, 0
  v_mov_b32 v105, 0
  v_mov_b32 v106, 0
  v_mov_b32 v107, 0
  v_mov_b32 v108, 0
  v_mov_b32 v109, 0
  v_mov_b32 v110, 0
  v_mov_b32 v111, 0
  s_barrier
  ds_read_b64_tr_b16 v[112:113], v10 offset:0
  ds_read_b64_tr_b16 v[114:115], v10 offset:1024
  ds_read_b64_tr_b16 v[116:117], v10 offset:512
  ds_read_b64_tr_b16 v[118:119], v10 offset:1536
  ds_read_b64_tr_b16 v[120:121], v10 offset:2048
  ds_read_b64_tr_b16 v[122:123], v10 offset:3072
  ds_read_b64_tr_b16 v[124:125], v10 offset:2560
  ds_read_b64_tr_b16 v[126:127], v10 offset:3584
  ds_read_b64_tr_b16 v[128:129], v10 offset:4096
  ds_read_b64_tr_b16 v[130:131], v10 offset:5120
  ds_read_b64_tr_b16 v[132:133], v10 offset:4608
  ds_read_b64_tr_b16 v[134:135], v10 offset:5632
  ds_read_b64_tr_b16 v[136:137], v10 offset:6144
  ds_read_b64_tr_b16 v[138:139], v10 offset:7168
  s_waitcnt vmcnt(28)
  s_waitcnt lgkmcnt(12)
  v_mfma_f32_32x32x16_bf16 v[48:63], v[144:147], v[112:115], v[48:63]
  s_add_u32 m0, s16, 0
  s_add_u32 s37, s24, 11264
  buffer_load_dwordx4 v12, s[28:31], s37 offen sc1 lds
  ds_read_b64_tr_b16 v[140:141], v10 offset:6656
  ds_read_b64_tr_b16 v[142:143], v10 offset:7680
  s_waitcnt vmcnt(28)
  s_waitcnt lgkmcnt(12)
  v_mfma_f32_32x32x16_bf16 v[48:63], v[148:151], v[116:119], v[48:63]
  ds_read_b64_tr_b16 v[112:113], v10 offset:8192
  ds_read_b64_tr_b16 v[114:115], v10 offset:9216
  s_waitcnt vmcnt(27)
  s_waitcnt lgkmcnt(12)
  v_mfma_f32_32x32x16_bf16 v[48:63], v[152:155], v[120:123], v[48:63]
  s_add_u32 m0, s16, 1024
  s_add_u32 s37, s24, 125952
  buffer_load_dwordx4 v12, s[28:31], s37 offen sc1 lds
  ds_read_b64_tr_b16 v[116:117], v10 offset:8704
  ds_read_b64_tr_b16 v[118:119], v10 offset:9728
  s_waitcnt vmcnt(27)
  s_waitcnt lgkmcnt(12)
  v_mfma_f32_32x32x16_bf16 v[48:63], v[156:159], v[124:127], v[48:63]
  ds_read_b64_tr_b16 v[120:121], v10 offset:10240
  ds_read_b64_tr_b16 v[122:123], v10 offset:11264
  s_waitcnt vmcnt(26)
  s_waitcnt lgkmcnt(12)
  v_mfma_f32_32x32x16_bf16 v[48:63], v[160:163], v[128:131], v[48:63]
  s_add_u32 m0, s16, 2048
  s_add_u32 s37, s24, 12288
  buffer_load_dwordx4 v12, s[28:31], s37 offen sc1 lds
  ds_read_b64_tr_b16 v[124:125], v10 offset:10752
  ds_read_b64_tr_b16 v[126:127], v10 offset:11776
  s_waitcnt vmcnt(26)
  s_waitcnt lgkmcnt(12)
  v_mfma_f32_32x32x16_bf16 v[48:63], v[164:167], v[132:135], v[48:63]
  ds_read_b64_tr_b16 v[128:129], v10 offset:12288
  ds_read_b64_tr_b16 v[130:131], v10 offset:13312
  s_waitcnt vmcnt(25)
  s_waitcnt lgkmcnt(12)
  v_mfma_f32_32x32x16_bf16 v[48:63], v[168:171], v[136:139], v[48:63]
  ds_read_b64_tr_b16 v[132:133], v10 offset:12800
  ds_read_b64_tr_b16 v[134:135], v10 offset:13824
  s_waitcnt vmcnt(24)
  s_waitcnt lgkmcnt(12)
  v_mfma_f32_32x32x16_bf16 v[48:63], v[172:175], v[140:143], v[48:63]
  ds_read_b64_tr_b16 v[136:137], v10 offset:28672
  ds_read_b64_tr_b16 v[138:139], v10 offset:29696
  s_waitcnt vmcnt(23)
  s_waitcnt lgkmcnt(12)
  v_mfma_f32_32x32x16_bf16 v[48:63], v[176:179], v[112:115], v[48:63]
  ds_read_b64_tr_b16 v[140:141], v10 offset:29184
  ds_read_b64_tr_b16 v[142:143], v10 offset:30208
  s_waitcnt vmcnt(22)
  s_waitcnt lgkmcnt(12)
  v_mfma_f32_32x32x16_bf16 v[48:63], v[180:183], v[116:119], v[48:63]
  ds_read_b64_tr_b16 v[112:113], v10 offset:30720
  ds_read_b64_tr_b16 v[114:115], v10 offset:31744
  s_waitcnt vmcnt(21)
  s_waitcnt lgkmcnt(12)
  v_mfma_f32_32x32x16_bf16 v[48:63], v[184:187], v[120:123], v[48:63]
  ds_read_b64_tr_b16 v[116:117], v10 offset:31232
  ds_read_b64_tr_b16 v[118:119], v10 offset:32256
  s_waitcnt vmcnt(20)
  s_waitcnt lgkmcnt(12)
  v_mfma_f32_32x32x16_bf16 v[48:63], v[188:191], v[124:127], v[48:63]
  ds_read_b64_tr_b16 v[120:121], v10 offset:32768
  ds_read_b64_tr_b16 v[122:123], v10 offset:33792
  s_waitcnt vmcnt(19)
  s_waitcnt lgkmcnt(12)
  v_mfma_f32_32x32x16_bf16 v[48:63], v[192:195], v[128:131], v[48:63]
  ds_read_b64_tr_b16 v[124:125], v10 offset:33280
  ds_read_b64_tr_b16 v[126:127], v10 offset:34304
  s_waitcnt vmcnt(18)
  s_waitcnt lgkmcnt(12)
  v_mfma_f32_32x32x16_bf16 v[48:63], v[196:199], v[132:135], v[48:63]
  ds_read_b64_tr_b16 v[128:129], v10 offset:34816
  ds_read_b64_tr_b16 v[130:131], v10 offset:35840
  s_waitcnt lgkmcnt(12)
  v_mfma_f32_32x32x16_bf16 v[64:79], v[144:147], v[136:139], v[64:79]
  s_add_u32 m0, s16, 3072
  s_add_u32 s37, s24, 126976
  buffer_load_dwordx4 v12, s[28:31], s37 offen sc1 lds
  ds_read_b64_tr_b16 v[132:133], v10 offset:35328
  ds_read_b64_tr_b16 v[134:135], v10 offset:36352
  s_waitcnt lgkmcnt(12)
  v_mfma_f32_32x32x16_bf16 v[64:79], v[148:151], v[140:143], v[64:79]
  ds_read_b64_tr_b16 v[136:137], v10 offset:36864
  ds_read_b64_tr_b16 v[138:139], v10 offset:37888
  s_waitcnt lgkmcnt(12)
  v_mfma_f32_32x32x16_bf16 v[64:79], v[152:155], v[112:115], v[64:79]
  s_add_u32 m0, s16, 4096
  s_add_u32 s37, s24, 13312
  buffer_load_dwordx4 v12, s[28:31], s37 offen sc1 lds
  ds_read_b64_tr_b16 v[140:141], v10 offset:37376
  ds_read_b64_tr_b16 v[142:143], v10 offset:38400
  s_waitcnt lgkmcnt(12)
  v_mfma_f32_32x32x16_bf16 v[64:79], v[156:159], v[116:119], v[64:79]
  ds_read_b64_tr_b16 v[112:113], v10 offset:38912
  ds_read_b64_tr_b16 v[114:115], v10 offset:39936
  s_waitcnt lgkmcnt(12)
  v_mfma_f32_32x32x16_bf16 v[64:79], v[160:163], v[120:123], v[64:79]
  s_add_u32 m0, s16, 5120
  s_add_u32 s37, s24, 128000
  buffer_load_dwordx4 v12, s[28:31], s37 offen sc1 lds
  ds_read_b64_tr_b16 v[116:117], v10 offset:39424
  ds_read_b64_tr_b16 v[118:119], v10 offset:40448
  s_waitcnt lgkmcnt(12)
  v_mfma_f32_32x32x16_bf16 v[64:79], v[164:167], v[124:127], v[64:79]
  ds_read_b64_tr_b16 v[120:121], v10 offset:40960
  ds_read_b64_tr_b16 v[122:123], v10 offset:41984
  s_waitcnt lgkmcnt(12)
  v_mfma_f32_32x32x16_bf16 v[64:79], v[168:171], v[128:131], v[64:79]
  ds_read_b64_tr_b16 v[124:125], v10 offset:41472
  ds_read_b64_tr_b16 v[126:127], v10 offset:42496
  s_waitcnt lgkmcnt(12)
  v_mfma_f32_32x32x16_bf16 v[64:79], v[172:175], v[132:135], v[64:79]
  ds_read_b64_tr_b16 v[128:129], v10 offset:14336
  ds_read_b64_tr_b16 v[130:131], v10 offset:15360
  s_waitcnt lgkmcnt(12)
  v_mfma_f32_32x32x16_bf16 v[64:79], v[176:179], v[136:139], v[64:79]
  ds_read_b64_tr_b16 v[132:133], v10 offset:14848
  ds_read_b64_tr_b16 v[134:135], v10 offset:15872
  s_waitcnt lgkmcnt(12)
  v_mfma_f32_32x32x16_bf16 v[64:79], v[180:183], v[140:143], v[64:79]
  ds_read_b64_tr_b16 v[136:137], v10 offset:16384
  ds_read_b64_tr_b16 v[138:139], v10 offset:17408
  s_waitcnt lgkmcnt(12)
  v_mfma_f32_32x32x16_bf16 v[64:79], v[184:187], v[112:115], v[64:79]
  ds_read_b64_tr_b16 v[140:141], v10 offset:16896
  ds_read_b64_tr_b16 v[142:143], v10 offset:17920
  s_waitcnt lgkmcnt(12)
  v_mfma_f32_32x32x16_bf16 v[64:79], v[188:191], v[116:119], v[64:79]
  ds_read_b64_tr_b16 v[112:113], v10 offset:18432
  ds_read_b64_tr_b16 v[114:115], v10 offset:19456
  s_waitcnt lgkmcnt(12)
  v_mfma_f32_32x32x16_bf16 v[64:79], v[192:195], v[120:123], v[64:79]
  ds_read_b64_tr_b16 v[116:117], v10 offset:18944
  ds_read_b64_tr_b16 v[118:119], v10 offset:19968
  s_waitcnt lgkmcnt(12)
  v_mfma_f32_32x32x16_bf16 v[64:79], v[196:199], v[124:127], v[64:79]
  s_barrier
  ds_read_b64_tr_b16 v[120:121], v10 offset:20480
  ds_read_b64_tr_b16 v[122:123], v10 offset:21504
  s_waitcnt vmcnt(20)
  s_waitcnt lgkmcnt(12)
  v_mfma_f32_32x32x16_bf16 v[48:63], v[200:203], v[128:131], v[48:63]
  s_add_u32 m0, s10, 0
  s_add_u32 s37, s9, 917504
  buffer_load_dwordx4 v12, s[28:31], s37 offen sc1 lds
  ds_read_b64_tr_b16 v[124:125], v10 offset:20992
  ds_read_b64_tr_b16 v[126:127], v10 offset:22016
  s_waitcnt vmcnt(20)
  s_waitcnt lgkmcnt(12)
  v_mfma_f32_32x32x16_bf16 v[48:63], v[204:207], v[132:135], v[48:63]
  ds_read_b64_tr_b16 v[128:129], v10 offset:22528
  ds_read_b64_tr_b16 v[130:131], v10 offset:23552
  s_waitcnt vmcnt(19)
  s_waitcnt lgkmcnt(12)
  v_mfma_f32_32x32x16_bf16 v[48:63], v[208:211], v[136:139], v[48:63]
  s_add_u32 m0, s10, 8192
  s_add_u32 s37, s9, 925696
  buffer_load_dwordx4 v12, s[28:31], s37 offen sc1 lds
  ds_read_b64_tr_b16 v[132:133], v10 offset:23040
  ds_read_b64_tr_b16 v[134:135], v10 offset:24064
  s_waitcnt vmcnt(19)
  s_waitcnt lgkmcnt(12)
  v_mfma_f32_32x32x16_bf16 v[48:63], v[212:215], v[140:143], v[48:63]
  ds_read_b64_tr_b16 v[136:137], v10 offset:24576
  ds_read_b64_tr_b16 v[138:139], v10 offset:25600
  s_waitcnt vmcnt(18)
  s_waitcnt lgkmcnt(12)
  v_mfma_f32_32x32x16_bf16 v[48:63], v[216:219], v[112:115], v[48:63]
  s_add_u32 m0, s10, 16384
  s_add_u32 s37, s9, 933888
  buffer_load_dwordx4 v12, s[28:31], s37 offen sc1 lds
  ds_read_b64_tr_b16 v[140:141], v10 offset:25088
  ds_read_b64_tr_b16 v[142:143], v10 offset:26112
  s_waitcnt vmcnt(18)
  s_waitcnt lgkmcnt(12)
  v_mfma_f32_32x32x16_bf16 v[48:63], v[220:223], v[116:119], v[48:63]
  ds_read_b64_tr_b16 v[112:113], v10 offset:26624
  ds_read_b64_tr_b16 v[114:115], v10 offset:27648
  s_waitcnt vmcnt(17)
  s_waitcnt lgkmcnt(12)
  v_mfma_f32_32x32x16_bf16 v[48:63], v[224:227], v[120:123], v[48:63]
  s_add_u32 m0, s10, 24576
  s_add_u32 s37, s9, 942080
  buffer_load_dwordx4 v12, s[28:31], s37 offen sc1 lds
  ds_read_b64_tr_b16 v[116:117], v10 offset:27136
  ds_read_b64_tr_b16 v[118:119], v10 offset:28160
  s_waitcnt vmcnt(17)
  s_waitcnt lgkmcnt(12)
  v_mfma_f32_32x32x16_bf16 v[48:63], v[228:231], v[124:127], v[48:63]
  ds_read_b64_tr_b16 v[120:121], v10 offset:43008
  ds_read_b64_tr_b16 v[122:123], v10 offset:44032
  s_waitcnt vmcnt(16)
  s_waitcnt lgkmcnt(12)
  v_mfma_f32_32x32x16_bf16 v[48:63], v[232:235], v[128:131], v[48:63]
  s_add_u32 m0, s10, 32768
  s_add_u32 s37, s9, 950272
  buffer_load_dwordx4 v12, s[28:31], s37 offen sc1 lds
  ds_read_b64_tr_b16 v[124:125], v10 offset:43520
  ds_read_b64_tr_b16 v[126:127], v10 offset:44544
  s_waitcnt vmcnt(16)
  s_waitcnt lgkmcnt(12)
  v_mfma_f32_32x32x16_bf16 v[48:63], v[236:239], v[132:135], v[48:63]
  ds_read_b64_tr_b16 v[128:129], v10 offset:45056
  ds_read_b64_tr_b16 v[130:131], v10 offset:46080
  s_waitcnt vmcnt(15)
  s_waitcnt lgkmcnt(12)
  v_mfma_f32_32x32x16_bf16 v[48:63], v[240:243], v[136:139], v[48:63]
  s_add_u32 m0, s10, 40960
  s_add_u32 s37, s9, 958464
  buffer_load_dwordx4 v12, s[28:31], s37 offen sc1 lds
  ds_read_b64_tr_b16 v[132:133], v10 offset:45568
  ds_read_b64_tr_b16 v[134:135], v10 offset:46592
  s_waitcnt vmcnt(15)
  s_waitcnt lgkmcnt(12)
  v_mfma_f32_32x32x16_bf16 v[48:63], v[244:247], v[140:143], v[48:63]
  ds_read_b64_tr_b16 v[136:137], v10 offset:47104
  ds_read_b64_tr_b16 v[138:139], v10 offset:48128
  s_waitcnt vmcnt(14)
  s_waitcnt lgkmcnt(12)
  v_mfma_f32_32x32x16_bf16 v[48:63], v[248:251], v[112:115], v[48:63]
  s_add_u32 m0, s10, 49152
  s_add_u32 s37, s9, 966656
  buffer_load_dwordx4 v12, s[28:31], s37 offen sc1 lds
  ds_read_b64_tr_b16 v[140:141], v10 offset:47616
  ds_read_b64_tr_b16 v[142:143], v10 offset:48640
  s_waitcnt vmcnt(14)
  s_waitcnt lgkmcnt(12)
  v_mfma_f32_32x32x16_bf16 v[48:63], v[252:255], v[116:119], v[48:63]
  ds_read_b64_tr_b16 v[112:113], v10 offset:49152
  ds_read_b64_tr_b16 v[114:115], v10 offset:50176
  s_waitcnt lgkmcnt(12)
  v_mfma_f32_32x32x16_bf16 v[64:79], v[200:203], v[120:123], v[64:79]
  ds_read_b64_tr_b16 v[116:117], v10 offset:49664
  ds_read_b64_tr_b16 v[118:119], v10 offset:50688
  s_waitcnt lgkmcnt(12)
  v_mfma_f32_32x32x16_bf16 v[64:79], v[204:207], v[124:127], v[64:79]
  ds_read_b64_tr_b16 v[120:121], v10 offset:51200
  ds_read_b64_tr_b16 v[122:123], v10 offset:52224
  s_waitcnt lgkmcnt(12)
  v_mfma_f32_32x32x16_bf16 v[64:79], v[208:211], v[128:131], v[64:79]
  ds_read_b64_tr_b16 v[124:125], v10 offset:51712
  ds_read_b64_tr_b16 v[126:127], v10 offset:52736
  s_waitcnt lgkmcnt(12)
  v_mfma_f32_32x32x16_bf16 v[64:79], v[212:215], v[132:135], v[64:79]
  ds_read_b64_tr_b16 v[128:129], v10 offset:53248
  ds_read_b64_tr_b16 v[130:131], v10 offset:54272
  s_waitcnt lgkmcnt(12)
  v_mfma_f32_32x32x16_bf16 v[64:79], v[216:219], v[136:139], v[64:79]
  ds_read_b64_tr_b16 v[132:133], v10 offset:53760
  ds_read_b64_tr_b16 v[134:135], v10 offset:54784
  s_waitcnt lgkmcnt(12)
  v_mfma_f32_32x32x16_bf16 v[64:79], v[220:223], v[140:143], v[64:79]
  ds_read_b64_tr_b16 v[136:137], v10 offset:55296
  ds_read_b64_tr_b16 v[138:139], v10 offset:56320
  s_waitcnt lgkmcnt(12)
  v_mfma_f32_32x32x16_bf16 v[64:79], v[224:227], v[112:115], v[64:79]
  ds_read_b64_tr_b16 v[140:141], v10 offset:55808
  ds_read_b64_tr_b16 v[142:143], v10 offset:56832
  s_waitcnt lgkmcnt(12)
  v_mfma_f32_32x32x16_bf16 v[64:79], v[228:231], v[116:119], v[64:79]
  s_waitcnt vmcnt(0)
  s_barrier
  ds_read_b64_tr_b16 v[112:113], v11 offset:0
  ds_read_b64_tr_b16 v[114:115], v11 offset:1024
  s_waitcnt lgkmcnt(12)
  v_mfma_f32_32x32x16_bf16 v[64:79], v[232:235], v[120:123], v[64:79]
  ds_read_b64_tr_b16 v[116:117], v11 offset:512
  ds_read_b64_tr_b16 v[118:119], v11 offset:1536
  s_waitcnt lgkmcnt(12)
  v_mfma_f32_32x32x16_bf16 v[64:79], v[236:239], v[124:127], v[64:79]
  ds_read_b64_tr_b16 v[120:121], v11 offset:2048
  ds_read_b64_tr_b16 v[122:123], v11 offset:3072
  s_waitcnt lgkmcnt(12)
  v_mfma_f32_32x32x16_bf16 v[64:79], v[240:243], v[128:131], v[64:79]
  ds_read_b64_tr_b16 v[124:125], v11 offset:2560
  ds_read_b64_tr_b16 v[126:127], v11 offset:3584
  s_waitcnt lgkmcnt(12)
  v_mfma_f32_32x32x16_bf16 v[64:79], v[244:247], v[132:135], v[64:79]
  ds_read_b64_tr_b16 v[128:129], v11 offset:4096
  ds_read_b64_tr_b16 v[130:131], v11 offset:5120
  s_waitcnt lgkmcnt(12)
  v_mfma_f32_32x32x16_bf16 v[64:79], v[248:251], v[136:139], v[64:79]
  ds_read_b64_tr_b16 v[132:133], v11 offset:4608
  ds_read_b64_tr_b16 v[134:135], v11 offset:5632
  s_waitcnt lgkmcnt(12)
  v_mfma_f32_32x32x16_bf16 v[64:79], v[252:255], v[140:143], v[64:79]
  ds_read_b64_tr_b16 v[136:137], v11 offset:6144
  ds_read_b64_tr_b16 v[138:139], v11 offset:7168
  s_waitcnt lgkmcnt(12)
  v_mfma_f32_32x32x16_bf16 v[80:95], v[144:147], v[112:115], v[80:95]
  ds_read_b64_tr_b16 v[140:141], v11 offset:6656
  ds_read_b64_tr_b16 v[142:143], v11 offset:7680
  s_waitcnt lgkmcnt(12)
  v_mfma_f32_32x32x16_bf16 v[80:95], v[148:151], v[116:119], v[80:95]
  ds_read_b64_tr_b16 v[112:113], v11 offset:8192
  ds_read_b64_tr_b16 v[114:115], v11 offset:9216
  s_waitcnt lgkmcnt(12)
  v_mfma_f32_32x32x16_bf16 v[80:95], v[152:155], v[120:123], v[80:95]
  ds_read_b64_tr_b16 v[116:117], v11 offset:8704
  ds_read_b64_tr_b16 v[118:119], v11 offset:9728
  s_waitcnt lgkmcnt(12)
  v_mfma_f32_32x32x16_bf16 v[80:95], v[156:159], v[124:127], v[80:95]
  ds_read_b64_tr_b16 v[120:121], v11 offset:10240
  ds_read_b64_tr_b16 v[122:123], v11 offset:11264
  s_waitcnt lgkmcnt(12)
  v_mfma_f32_32x32x16_bf16 v[80:95], v[160:163], v[128:131], v[80:95]
  s_barrier
  ds_read_b64 v[20:21], v13 offset:0
  ds_read_b64 v[24:25], v9 offset:0
  ds_read_b64_tr_b16 v[124:125], v11 offset:10752
  ds_read_b64_tr_b16 v[126:127], v11 offset:11776
  s_waitcnt lgkmcnt(14)
  v_mfma_f32_32x32x16_bf16 v[80:95], v[164:167], v[132:135], v[80:95]
  ds_read_b64_tr_b16 v[128:129], v11 offset:12288
  ds_read_b64_tr_b16 v[130:131], v11 offset:13312
  s_waitcnt lgkmcnt(14)
  v_mfma_f32_32x32x16_bf16 v[80:95], v[168:171], v[136:139], v[80:95]
  s_waitcnt lgkmcnt(4)
  v_mfma_f32_32x32x16_bf16 v[48:63], v[16:19], v[20:23], v[48:63]
  s_add_u32 m0, s18, 0
  s_add_u32 s37, s24, 7168
  buffer_load_dwordx4 v12, s[28:31], s37 offen sc1 lds
  ds_read_b64_tr_b16 v[132:133], v11 offset:12800
  ds_read_b64_tr_b16 v[134:135], v11 offset:13824
  v_mfma_f32_32x32x16_bf16 v[80:95], v[172:175], v[140:143], v[80:95]
  s_nop 5
  v_mul_f32 v26, v24, v48
  v_mul_f32 v27, v24, v49
  v_exp_f32 v26, v26
  v_exp_f32 v27, v27
  v_mul_f32 v48, v48, v56
  ds_read_b64_tr_b16 v[136:137], v11 offset:28672
  ds_read_b64_tr_b16 v[138:139], v11 offset:29696
  v_mfma_f32_32x32x16_bf16 v[80:95], v[176:179], v[112:115], v[80:95]
  s_add_u32 m0, s18, 1024
  s_add_u32 s37, s24, 121856
  buffer_load_dwordx4 v12, s[28:31], s37 offen sc1 lds
  v_mul_f32 v49, v49, v57
  v_fma_f32 v26, v26, v25, v25
  v_fma_f32 v27, v27, v25, v25
  v_rcp_f32 v26, v26
  v_rcp_f32 v27, v27
  ds_read_b64_tr_b16 v[140:141], v11 offset:29184
  ds_read_b64_tr_b16 v[142:143], v11 offset:30208
  v_mfma_f32_32x32x16_bf16 v[80:95], v[180:183], v[116:119], v[80:95]
  v_mul_f32 v48, v48, v26
  v_mul_f32 v49, v49, v27
  v_cvt_pk_bf16_f32 v32, v48, v49
  v_mul_f32 v28, v24, v50
  v_mul_f32 v29, v24, v51
  ds_read_b64_tr_b16 v[112:113], v11 offset:30720
  ds_read_b64_tr_b16 v[114:115], v11 offset:31744
  v_mfma_f32_32x32x16_bf16 v[80:95], v[184:187], v[120:123], v[80:95]
  s_add_u32 m0, s18, 2048
  s_add_u32 s37, s24, 8192
  buffer_load_dwordx4 v12, s[28:31], s37 offen sc1 lds
  v_exp_f32 v28, v28
  v_exp_f32 v29, v29
  v_mul_f32 v50, v50, v58
  v_mul_f32 v51, v51, v59
  v_fma_f32 v28, v28, v25, v25
  ds_read_b64_tr_b16 v[116:117], v11 offset:31232
  ds_read_b64_tr_b16 v[118:119], v11 offset:32256
  s_waitcnt lgkmcnt(12)
  v_mfma_f32_32x32x16_bf16 v[80:95], v[188:191], v[124:127], v[80:95]
  v_fma_f32 v29, v29, v25, v25
  v_rcp_f32 v28, v28
  v_rcp_f32 v29, v29
  v_mul_f32 v50, v50, v28
  v_mul_f32 v51, v51, v29
  ds_read_b64_tr_b16 v[120:121], v11 offset:32768
  ds_read_b64_tr_b16 v[122:123], v11 offset:33792
  s_waitcnt lgkmcnt(12)
  v_mfma_f32_32x32x16_bf16 v[80:95], v[192:195], v[128:131], v[80:95]
  v_cvt_pk_bf16_f32 v33, v50, v51
  v_mul_f32 v26, v24, v52
  v_mul_f32 v27, v24, v53
  v_exp_f32 v26, v26
  v_exp_f32 v27, v27
  ds_read_b64_tr_b16 v[124:125], v11 offset:33280
  ds_read_b64_tr_b16 v[126:127], v11 offset:34304
  s_waitcnt lgkmcnt(12)
  v_mfma_f32_32x32x16_bf16 v[80:95], v[196:199], v[132:135], v[80:95]
  v_mul_f32 v52, v52, v60
  v_mul_f32 v53, v53, v61
  v_fma_f32 v26, v26, v25, v25
  v_fma_f32 v27, v27, v25, v25
  v_rcp_f32 v26, v26
  ds_read_b64_tr_b16 v[128:129], v11 offset:34816
  ds_read_b64_tr_b16 v[130:131], v11 offset:35840
  s_waitcnt lgkmcnt(12)
  v_mfma_f32_32x32x16_bf16 v[96:111], v[144:147], v[136:139], v[96:111]
  s_add_u32 m0, s18, 3072
  s_add_u32 s37, s24, 122880
  buffer_load_dwordx4 v12, s[28:31], s37 offen sc1 lds
  v_rcp_f32 v27, v27
  v_mul_f32 v52, v52, v26
  v_mul_f32 v53, v53, v27
  v_cvt_pk_bf16_f32 v34, v52, v53
  v_mul_f32 v28, v24, v54
  ds_read_b64_tr_b16 v[132:133], v11 offset:35328
  ds_read_b64_tr_b16 v[134:135], v11 offset:36352
  s_waitcnt lgkmcnt(12)
  v_mfma_f32_32x32x16_bf16 v[96:111], v[148:151], v[140:143], v[96:111]
  v_mul_f32 v29, v24, v55
  v_exp_f32 v28, v28
  v_exp_f32 v29, v29
  v_mul_f32 v54, v54, v62
  v_mul_f32 v55, v55, v63
  ds_read_b64_tr_b16 v[136:137], v11 offset:36864
  ds_read_b64_tr_b16 v[138:139], v11 offset:37888
  s_waitcnt lgkmcnt(12)
  v_mfma_f32_32x32x16_bf16 v[96:111], v[152:155], v[112:115], v[96:111]
  s_add_u32 m0, s18, 4096
  s_add_u32 s37, s24, 9216
  buffer_load_dwordx4 v12, s[28:31], s37 offen sc1 lds
  v_fma_f32 v28, v28, v25, v25
  v_fma_f32 v29, v29, v25, v25
  v_rcp_f32 v28, v28
  v_rcp_f32 v29, v29
  v_mul_f32 v54, v54, v28
  ds_read_b64_tr_b16 v[140:141], v11 offset:37376
  ds_read_b64_tr_b16 v[142:143], v11 offset:38400
  s_waitcnt lgkmcnt(12)
  v_mfma_f32_32x32x16_bf16 v[96:111], v[156:159], v[116:119], v[96:111]
  v_mul_f32 v55, v55, v29
  v_cvt_pk_bf16_f32 v35, v54, v55
  s_add_u32 s37, s14, 0
  buffer_store_dwordx4 v[32:35], v12, s[28:31], s37 offen sc1
  ds_read_b64 v[20:21], v13 offset:768
  ds_read_b64 v[24:25], v9 offset:768
  ds_read_b64_tr_b16 v[112:113], v11 offset:38912
  ds_read_b64_tr_b16 v[114:115], v11 offset:39936
  s_waitcnt lgkmcnt(14)
  v_mfma_f32_32x32x16_bf16 v[96:111], v[160:163], v[120:123], v[96:111]
  s_add_u32 m0, s18, 5120
  s_add_u32 s37, s24, 123904
  buffer_load_dwordx4 v12, s[28:31], s37 offen sc1 lds
  ds_read_b64_tr_b16 v[116:117], v11 offset:39424
  ds_read_b64_tr_b16 v[118:119], v11 offset:40448
  s_waitcnt lgkmcnt(14)
  v_mfma_f32_32x32x16_bf16 v[96:111], v[164:167], v[124:127], v[96:111]
  s_waitcnt lgkmcnt(4)
  v_mfma_f32_32x32x16_bf16 v[64:79], v[16:19], v[20:23], v[64:79]
  ds_read_b64_tr_b16 v[120:121], v11 offset:40960
  ds_read_b64_tr_b16 v[122:123], v11 offset:41984
  v_mfma_f32_32x32x16_bf16 v[96:111], v[168:171], v[128:131], v[96:111]
  s_add_u32 m0, s18, 6144
  s_add_u32 s37, s24, 10240
  buffer_load_dwordx4 v12, s[28:31], s37 offen sc1 lds
  s_nop 5
  v_mul_f32 v26, v24, v64
  v_mul_f32 v27, v24, v65
  v_exp_f32 v26, v26
  v_exp_f32 v27, v27
  v_mul_f32 v64, v64, v72
  ds_read_b64_tr_b16 v[124:125], v11 offset:41472
  ds_read_b64_tr_b16 v[126:127], v11 offset:42496
  v_mfma_f32_32x32x16_bf16 v[96:111], v[172:175], v[132:135], v[96:111]
  v_mul_f32 v65, v65, v73
  v_fma_f32 v26, v26, v25, v25
  v_fma_f32 v27, v27, v25, v25
  v_rcp_f32 v26, v26
  v_rcp_f32 v27, v27
  ds_read_b64_tr_b16 v[128:129], v11 offset:14336
  ds_read_b64_tr_b16 v[130:131], v11 offset:15360
  v_mfma_f32_32x32x16_bf16 v[96:111], v[176:179], v[136:139], v[96:111]
  s_add_u32 m0, s18, 7168
  s_add_u32 s37, s24, 124928
  buffer_load_dwordx4 v12, s[28:31], s37 offen sc1 lds
  v_mul_f32 v64, v64, v26
  v_mul_f32 v65, v65, v27
  v_cvt_pk_bf16_f32 v32, v64, v65
  v_mul_f32 v28, v24, v66
  v_mul_f32 v29, v24, v67
  ds_read_b64_tr_b16 v[132:133], v11 offset:14848
  ds_read_b64_tr_b16 v[134:135], v11 offset:15872
  v_mfma_f32_32x32x16_bf16 v[96:111], v[180:183], v[140:143], v[96:111]
  v_exp_f32 v28, v28
  v_exp_f32 v29, v29
  v_mul_f32 v66, v66, v74
  v_mul_f32 v67, v67, v75
  v_fma_f32 v28, v28, v25, v25
  ds_read_b64_tr_b16 v[136:137], v11 offset:16384
  ds_read_b64_tr_b16 v[138:139], v11 offset:17408
  s_waitcnt lgkmcnt(12)
  v_mfma_f32_32x32x16_bf16 v[96:111], v[184:187], v[112:115], v[96:111]
  v_fma_f32 v29, v29, v25, v25
  v_rcp_f32 v28, v28
  v_rcp_f32 v29, v29
  v_mul_f32 v66, v66, v28
  v_mul_f32 v67, v67, v29
  ds_read_b64_tr_b16 v[140:141], v11 offset:16896
  ds_read_b64_tr_b16 v[142:143], v11 offset:17920
  s_waitcnt lgkmcnt(12)
  v_mfma_f32_32x32x16_bf16 v[96:111], v[188:191], v[116:119], v[96:111]
  v_cvt_pk_bf16_f32 v33, v66, v67
  v_mul_f32 v26, v24, v68
  v_mul_f32 v27, v24, v69
  v_exp_f32 v26, v26
  v_exp_f32 v27, v27
  ds_read_b64_tr_b16 v[112:113], v11 offset:18432
  ds_read_b64_tr_b16 v[114:115], v11 offset:19456
  s_waitcnt lgkmcnt(12)
  v_mfma_f32_32x32x16_bf16 v[96:111], v[192:195], v[120:123], v[96:111]
  v_mul_f32 v68, v68, v76
  v_mul_f32 v69, v69, v77
  v_fma_f32 v26, v26, v25, v25
  v_fma_f32 v27, v27, v25, v25
  v_rcp_f32 v26, v26
  ds_read_b64_tr_b16 v[116:117], v11 offset:18944
  ds_read_b64_tr_b16 v[118:119], v11 offset:19968
  s_waitcnt lgkmcnt(12)
  v_mfma_f32_32x32x16_bf16 v[96:111], v[196:199], v[124:127], v[96:111]
  v_rcp_f32 v27, v27
  v_mul_f32 v68, v68, v26
  v_mul_f32 v69, v69, v27
  v_cvt_pk_bf16_f32 v34, v68, v69
  v_mul_f32 v28, v24, v70
  ds_read_b64_tr_b16 v[120:121], v11 offset:20480
  ds_read_b64_tr_b16 v[122:123], v11 offset:21504
  s_waitcnt lgkmcnt(12)
  v_mfma_f32_32x32x16_bf16 v[80:95], v[200:203], v[128:131], v[80:95]
  s_add_u32 s37, s24, 0
  buffer_load_dwordx4 v[144:147], v12, s[28:31], s37 offen sc1
  v_mul_f32 v29, v24, v71
  v_exp_f32 v28, v28
  v_exp_f32 v29, v29
  v_mul_f32 v70, v70, v78
  v_mul_f32 v71, v71, v79
  ds_read_b64_tr_b16 v[124:125], v11 offset:20992
  ds_read_b64_tr_b16 v[126:127], v11 offset:22016
  s_waitcnt lgkmcnt(12)
  v_mfma_f32_32x32x16_bf16 v[80:95], v[204:207], v[132:135], v[80:95]
  v_fma_f32 v28, v28, v25, v25
  v_fma_f32 v29, v29, v25, v25
  v_rcp_f32 v28, v28
  v_rcp_f32 v29, v29
  v_mul_f32 v70, v70, v28
  ds_read_b64_tr_b16 v[128:129], v11 offset:22528
  ds_read_b64_tr_b16 v[130:131], v11 offset:23552
  s_waitcnt lgkmcnt(12)
  v_mfma_f32_32x32x16_bf16 v[80:95], v[208:211], v[136:139], v[80:95]
  s_add_u32 s37, s24, 114688
  buffer_load_dwordx4 v[148:151], v12, s[28:31], s37 offen sc1
  v_mul_f32 v71, v71, v29
  v_cvt_pk_bf16_f32 v35, v70, v71
  s_add_u32 s37, s14, 114688
  buffer_store_dwordx4 v[32:35], v12, s[28:31], s37 offen sc1
  ds_read_b64_tr_b16 v[132:133], v11 offset:23040
  ds_read_b64_tr_b16 v[134:135], v11 offset:24064
  s_waitcnt lgkmcnt(12)
  v_mfma_f32_32x32x16_bf16 v[80:95], v[212:215], v[140:143], v[80:95]
  ds_read_b64_tr_b16 v[136:137], v11 offset:24576
  ds_read_b64_tr_b16 v[138:139], v11 offset:25600
  s_waitcnt lgkmcnt(12)
  v_mfma_f32_32x32x16_bf16 v[80:95], v[216:219], v[112:115], v[80:95]
  s_add_u32 s37, s24, 1024
  buffer_load_dwordx4 v[152:155], v12, s[28:31], s37 offen sc1
  ds_read_b64_tr_b16 v[140:141], v11 offset:25088
  ds_read_b64_tr_b16 v[142:143], v11 offset:26112
  s_waitcnt lgkmcnt(12)
  v_mfma_f32_32x32x16_bf16 v[80:95], v[220:223], v[116:119], v[80:95]
  ds_read_b64_tr_b16 v[112:113], v11 offset:26624
  ds_read_b64_tr_b16 v[114:115], v11 offset:27648
  s_waitcnt lgkmcnt(12)
  v_mfma_f32_32x32x16_bf16 v[80:95], v[224:227], v[120:123], v[80:95]
  s_add_u32 s37, s24, 115712
  buffer_load_dwordx4 v[156:159], v12, s[28:31], s37 offen sc1
  ds_read_b64_tr_b16 v[116:117], v11 offset:27136
  ds_read_b64_tr_b16 v[118:119], v11 offset:28160
  s_waitcnt lgkmcnt(12)
  v_mfma_f32_32x32x16_bf16 v[80:95], v[228:231], v[124:127], v[80:95]
  ds_read_b64_tr_b16 v[120:121], v11 offset:43008
  ds_read_b64_tr_b16 v[122:123], v11 offset:44032
  s_waitcnt lgkmcnt(12)
  v_mfma_f32_32x32x16_bf16 v[80:95], v[232:235], v[128:131], v[80:95]
  s_add_u32 s37, s24, 2048
  buffer_load_dwordx4 v[160:163], v12, s[28:31], s37 offen sc1
  ds_read_b64_tr_b16 v[124:125], v11 offset:43520
  ds_read_b64_tr_b16 v[126:127], v11 offset:44544
  s_waitcnt lgkmcnt(12)
  v_mfma_f32_32x32x16_bf16 v[80:95], v[236:239], v[132:135], v[80:95]
  ds_read_b64_tr_b16 v[128:129], v11 offset:45056
  ds_read_b64_tr_b16 v[130:131], v11 offset:46080
  s_waitcnt lgkmcnt(12)
  v_mfma_f32_32x32x16_bf16 v[80:95], v[240:243], v[136:139], v[80:95]
  s_add_u32 s37, s24, 116736
  buffer_load_dwordx4 v[164:167], v12, s[28:31], s37 offen sc1
  ds_read_b64_tr_b16 v[132:133], v11 offset:45568
  ds_read_b64_tr_b16 v[134:135], v11 offset:46592
  s_waitcnt lgkmcnt(12)
  v_mfma_f32_32x32x16_bf16 v[80:95], v[244:247], v[140:143], v[80:95]
  ds_read_b64_tr_b16 v[136:137], v11 offset:47104
  ds_read_b64_tr_b16 v[138:139], v11 offset:48128
  s_waitcnt lgkmcnt(12)
  v_mfma_f32_32x32x16_bf16 v[80:95], v[248:251], v[112:115], v[80:95]
  s_add_u32 s37, s24, 3072
  buffer_load_dwordx4 v[168:171], v12, s[28:31], s37 offen sc1
  ds_read_b64_tr_b16 v[140:141], v11 offset:47616
  ds_read_b64_tr_b16 v[142:143], v11 offset:48640
  s_waitcnt lgkmcnt(12)
  v_mfma_f32_32x32x16_bf16 v[80:95], v[252:255], v[116:119], v[80:95]
  s_waitcnt vmcnt(5)
  s_barrier
  ds_read_b64 v[20:21], v13 offset:1536
  ds_read_b64 v[24:25], v9 offset:1536
  ds_read_b64_tr_b16 v[112:113], v11 offset:49152
  ds_read_b64_tr_b16 v[114:115], v11 offset:50176
  s_waitcnt lgkmcnt(14)
  v_mfma_f32_32x32x16_bf16 v[96:111], v[200:203], v[120:123], v[96:111]
  s_add_u32 s37, s24, 117760
  buffer_load_dwordx4 v[172:175], v12, s[28:31], s37 offen sc1
  ds_read_b64_tr_b16 v[116:117], v11 offset:49664
  ds_read_b64_tr_b16 v[118:119], v11 offset:50688
  s_waitcnt lgkmcnt(14)
  v_mfma_f32_32x32x16_bf16 v[96:111], v[204:207], v[124:127], v[96:111]
  s_waitcnt lgkmcnt(4)
  v_mfma_f32_32x32x16_bf16 v[80:95], v[16:19], v[20:23], v[80:95]
  ds_read_b64_tr_b16 v[120:121], v11 offset:51200
  ds_read_b64_tr_b16 v[122:123], v11 offset:52224
  v_mfma_f32_32x32x16_bf16 v[96:111], v[208:211], v[128:131], v[96:111]
  s_add_u32 s37, s24, 4096
  buffer_load_dwordx4 v[176:179], v12, s[28:31], s37 offen sc1
  s_nop 6
  v_mul_f32 v26, v24, v80
  v_mul_f32 v27, v24, v81
  v_exp_f32 v26, v26
  v_exp_f32 v27, v27
  v_mul_f32 v80, v80, v88
  ds_read_b64_tr_b16 v[124:125], v11 offset:51712
  ds_read_b64_tr_b16 v[126:127], v11 offset:52736
  v_mfma_f32_32x32x16_bf16 v[96:111], v[212:215], v[132:135], v[96:111]
  v_mul_f32 v81, v81, v89
  v_fma_f32 v26, v26, v25, v25
  v_fma_f32 v27, v27, v25, v25
  v_rcp_f32 v26, v26
  v_rcp_f32 v27, v27
  ds_read_b64_tr_b16 v[128:129], v11 offset:53248
  ds_read_b64_tr_b16 v[130:131], v11 offset:54272
  v_mfma_f32_32x32x16_bf16 v[96:111], v[216:219], v[136:139], v[96:111]
  s_add_u32 s37, s24, 118784
  buffer_load_dwordx4 v[180:183], v12, s[28:31], s37 offen sc1
  v_mul_f32 v80, v80, v26
  v_mul_f32 v81, v81, v27
  v_cvt_pk_bf16_f32 v32, v80, v81
  v_mul_f32 v28, v24, v82
  v_mul_f32 v29, v24, v83
  ds_read_b64_tr_b16 v[132:133], v11 offset:53760
  ds_read_b64_tr_b16 v[134:135], v11 offset:54784
  v_mfma_f32_32x32x16_bf16 v[96:111], v[220:223], v[140:143], v[96:111]
  v_exp_f32 v28, v28
  v_exp_f32 v29, v29
  v_mul_f32 v82, v82, v90
  v_mul_f32 v83, v83, v91
  v_fma_f32 v28, v28, v25, v25
  ds_read_b64_tr_b16 v[136:137], v11 offset:55296
  ds_read_b64_tr_b16 v[138:139], v11 offset:56320
  s_waitcnt lgkmcnt(12)
  v_mfma_f32_32x32x16_bf16 v[96:111], v[224:227], v[112:115], v[96:111]
  s_add_u32 s37, s24, 5120
  buffer_load_dwordx4 v[184:187], v12, s[28:31], s37 offen sc1
  v_fma_f32 v29, v29, v25, v25
  v_rcp_f32 v28, v28
  v_rcp_f32 v29, v29
  v_mul_f32 v82, v82, v28
  v_mul_f32 v83, v83, v29
  ds_read_b64_tr_b16 v[140:141], v11 offset:55808
  ds_read_b64_tr_b16 v[142:143], v11 offset:56832
  s_waitcnt lgkmcnt(12)
  v_mfma_f32_32x32x16_bf16 v[96:111], v[228:231], v[116:119], v[96:111]
  v_cvt_pk_bf16_f32 v33, v82, v83
  v_mul_f32 v26, v24, v84
  v_mul_f32 v27, v24, v85
  v_exp_f32 v26, v26
  v_exp_f32 v27, v27
  s_waitcnt lgkmcnt(10)
  v_mfma_f32_32x32x16_bf16 v[96:111], v[232:235], v[120:123], v[96:111]
  s_add_u32 s37, s24, 119808
  buffer_load_dwordx4 v[188:191], v12, s[28:31], s37 offen sc1
  v_mul_f32 v84, v84, v92
  v_mul_f32 v85, v85, v93
  v_fma_f32 v26, v26, v25, v25
  v_fma_f32 v27, v27, v25, v25
  v_rcp_f32 v26, v26
  s_waitcnt lgkmcnt(8)
  v_mfma_f32_32x32x16_bf16 v[96:111], v[236:239], v[124:127], v[96:111]
  v_rcp_f32 v27, v27
  v_mul_f32 v84, v84, v26
  v_mul_f32 v85, v85, v27
  v_cvt_pk_bf16_f32 v34, v84, v85
  v_mul_f32 v28, v24, v86
  s_waitcnt lgkmcnt(6)
  v_mfma_f32_32x32x16_bf16 v[96:111], v[240:243], v[128:131], v[96:111]
  s_add_u32 s37, s24, 6144
  buffer_load_dwordx4 v[192:195], v12, s[28:31], s37 offen sc1
  v_mul_f32 v29, v24, v87
  v_exp_f32 v28, v28
  v_exp_f32 v29, v29
  v_mul_f32 v86, v86, v94
  v_mul_f32 v87, v87, v95
  s_waitcnt lgkmcnt(4)
  v_mfma_f32_32x32x16_bf16 v[96:111], v[244:247], v[132:135], v[96:111]
  v_fma_f32 v28, v28, v25, v25
  v_fma_f32 v29, v29, v25, v25
  v_rcp_f32 v28, v28
  v_rcp_f32 v29, v29
  v_mul_f32 v86, v86, v28
  s_waitcnt lgkmcnt(2)
  v_mfma_f32_32x32x16_bf16 v[96:111], v[248:251], v[136:139], v[96:111]
  s_add_u32 s37, s24, 120832
  buffer_load_dwordx4 v[196:199], v12, s[28:31], s37 offen sc1
  v_mul_f32 v87, v87, v29
  v_cvt_pk_bf16_f32 v35, v86, v87
  s_add_u32 s37, s14, 3670016
  buffer_store_dwordx4 v[32:35], v12, s[28:31], s37 offen sc1
  s_waitcnt lgkmcnt(0)
  v_mfma_f32_32x32x16_bf16 v[96:111], v[252:255], v[140:143], v[96:111]
  s_barrier
  ds_read_b64 v[20:21], v13 offset:2304
  ds_read_b64 v[24:25], v9 offset:2304
  s_waitcnt lgkmcnt(0)
  v_mfma_f32_32x32x16_bf16 v[96:111], v[16:19], v[20:23], v[96:111]
  v_add_u32 v14, s16, v12
  v_add_u32 v15, s18, v12
  ds_read_b128 v[232:235], v14 offset:0
  ds_read_b128 v[236:239], v14 offset:1024
  ds_read_b128 v[240:243], v14 offset:2048
  ds_read_b128 v[244:247], v14 offset:3072
  ds_read_b128 v[248:251], v14 offset:4096
  ds_read_b128 v[252:255], v14 offset:5120
  s_nop 3
  v_mul_f32 v26, v24, v96
  v_mul_f32 v27, v24, v97
  v_exp_f32 v26, v26
  v_exp_f32 v27, v27
  v_mul_f32 v96, v96, v104
  v_mul_f32 v97, v97, v105
  v_fma_f32 v26, v26, v25, v25
  v_fma_f32 v27, v27, v25, v25
  v_rcp_f32 v26, v26
  v_rcp_f32 v27, v27
  v_mul_f32 v96, v96, v26
  v_mul_f32 v97, v97, v27
  v_cvt_pk_bf16_f32 v32, v96, v97
  v_mul_f32 v28, v24, v98
  v_mul_f32 v29, v24, v99
  v_exp_f32 v28, v28
  v_exp_f32 v29, v29
  v_mul_f32 v98, v98, v106
  v_mul_f32 v99, v99, v107
  v_fma_f32 v28, v28, v25, v25
  v_fma_f32 v29, v29, v25, v25
  v_rcp_f32 v28, v28
  v_rcp_f32 v29, v29
  v_mul_f32 v98, v98, v28
  v_mul_f32 v99, v99, v29
  v_cvt_pk_bf16_f32 v33, v98, v99
  v_mul_f32 v26, v24, v100
  v_mul_f32 v27, v24, v101
  v_exp_f32 v26, v26
  v_exp_f32 v27, v27
  v_mul_f32 v100, v100, v108
  v_mul_f32 v101, v101, v109
  v_fma_f32 v26, v26, v25, v25
  v_fma_f32 v27, v27, v25, v25
  v_rcp_f32 v26, v26
  v_rcp_f32 v27, v27
  v_mul_f32 v100, v100, v26
  v_mul_f32 v101, v101, v27
  v_cvt_pk_bf16_f32 v34, v100, v101
  v_mul_f32 v28, v24, v102
  v_mul_f32 v29, v24, v103
  v_exp_f32 v28, v28
  v_exp_f32 v29, v29
  v_mul_f32 v102, v102, v110
  v_mul_f32 v103, v103, v111
  v_fma_f32 v28, v28, v25, v25
  v_fma_f32 v29, v29, v25, v25
  v_rcp_f32 v28, v28
  v_rcp_f32 v29, v29
  v_mul_f32 v102, v102, v28
  v_mul_f32 v103, v103, v29
  v_cvt_pk_bf16_f32 v35, v102, v103
  s_add_u32 s37, s14, 3784704
  buffer_store_dwordx4 v[32:35], v12, s[28:31], s37 offen sc1
  ds_read_b128 v[200:203], v15 offset:0
  ds_read_b128 v[204:207], v15 offset:1024
  ds_read_b128 v[208:211], v15 offset:2048
  ds_read_b128 v[212:215], v15 offset:3072
  ds_read_b128 v[216:219], v15 offset:4096
  ds_read_b128 v[220:223], v15 offset:5120
  ds_read_b128 v[224:227], v15 offset:6144
  ds_read_b128 v[228:231], v15 offset:7168
  s_branch D_ENTRY
C_STATS:
  v_lshrrev_b32 v6, 2, v2
  v_lshlrev_b32 v6, 6, v6
  v_and_b32 v7, 3, v2
  v_lshl_add_u32 v11, v7, 3, v6
  v_add_u32 v10, 102400, v11
  v_cmp_eq_u32 s[44:45], 1, v7
  v_cmp_eq_u32 s[46:47], 2, v7
  v_cmp_eq_u32 s[48:49], 3, v7
  v_lshrrev_b32 v6, 4, v2
  v_bfe_u32 v7, v2, 2, 2
  v_cmp_eq_u32 s[50:51], v6, v7
  v_and_b32 v9, 15, v2
  v_lshlrev_b32 v9, 3, v9
  v_add_u32 v9, 159872, v9
  v_mov_b32 v40, 0x3f803f80
  v_mov_b32 v41, 0x3f803f80
  v_mov_b32 v42, 0x3f803f80
  v_mov_b32 v43, 0x3f803f80
  s_mul_i32 s9, s6, 57344
  s_add_u32 s9, s9, 1048576
  v_mov_b32 v48, 0
  v_mov_b32 v49, 0
  v_mov_b32 v50, 0
  v_mov_b32 v51, 0
  v_mov_b32 v52, 0
  v_mov_b32 v53, 0
  v_mov_b32 v54, 0
  v_mov_b32 v55, 0
  v_mov_b32 v56, 0
  v_mov_b32 v57, 0
  v_mov_b32 v58, 0
  v_mov_b32 v59, 0
  v_mov_b32 v60, 0
  v_mov_b32 v61, 0
  v_mov_b32 v62, 0
  v_mov_b32 v63, 0
  v_mov_b32 v64, 0
  v_mov_b32 v65, 0
  v_mov_b32 v66, 0
  v_mov_b32 v67, 0
  v_mov_b32 v68, 0
  v_mov_b32 v69, 0
  v_mov_b32 v70, 0
  v_mov_b32 v71, 0
  v_mov_b32 v72, 0
  v_mov_b32 v73, 0
  v_mov_b32 v74, 0
  v_mov_b32 v75, 0
  v_mov_b32 v76, 0
  v_mov_b32 v77, 0
  v_mov_b32 v78, 0
  v_mov_b32 v79, 0
  v_mov_b32 v80, 0
  v_mov_b32 v81, 0
  v_mov_b32 v82, 0
  v_mov_b32 v83, 0
  v_mov_b32 v84, 0
  v_mov_b32 v85, 0
  v_mov_b32 v86, 0
  v_mov_b32 v87, 0
  v_mov_b32 v88, 0
  v_mov_b32 v89, 0
  v_mov_b32 v90, 0
  v_mov_b32 v91, 0
  v_mov_b32 v92, 0
  v_mov_b32 v93, 0
  v_mov_b32 v94, 0
  v_mov_b32 v95, 0
  v_mov_b32 v96, 0
  v_mov_b32 v97, 0
  v_mov_b32 v98, 0
  v_mov_b32 v99, 0
  v_mov_b32 v100, 0
  v_mov_b32 v101, 0
  v_mov_b32 v102, 0
  v_mov_b32 v103, 0
  v_mov_b32 v104, 0
  v_mov_b32 v105, 0
  v_mov_b32 v106, 0
  v_mov_b32 v107, 0
  v_mov_b32 v108, 0
  v_mov_b32 v109, 0
  v_mov_b32 v110, 0
  v_mov_b32 v111, 0
  v_lshlrev_b32 v16, 6, v2
  s_mov_b32 s38, 0
  s_mov_b64 s[40:41], -1
  s_mov_b64 s[42:43], -1
  s_mov_b64 s[76:77], -1
  s_mov_b64 s[78:79], -1
PA_32:
  s_mov_b64 exec, s[40:41]
  s_cbranch_execz PA_32_0
  s_mov_b32 s39, 163840
  buffer_load_dword v17, v16, s[28:31], s39 offen sc1
PA_32_0:
  s_mov_b64 exec, s[42:43]
  s_cbranch_execz PA_32_1
  s_mov_b32 s39, 167936
  buffer_load_dword v18, v16, s[28:31], s39 offen sc1
PA_32_1:
  s_mov_b64 exec, s[76:77]
  s_cbranch_execz PA_32_2
  s_mov_b32 s39, 172032
  buffer_load_dword v19, v16, s[28:31], s39 offen sc1
PA_32_2:
  s_mov_b64 exec, s[78:79]
  s_cbranch_execz PA_32_3
  s_mov_b32 s39, 176128
  buffer_load_dword v20, v16, s[28:31], s39 offen sc1
PA_32_3:
  s_mov_b64 exec, -1
  s_waitcnt vmcnt(0)
  v_cmp_ne_u32 vcc, 1, v17
  s_nop 0
  s_and_b64 s[40:41], s[40:41], vcc
  v_cmp_ne_u32 vcc, 1, v18
  s_nop 0
  s_and_b64 s[42:43], s[42:43], vcc
  v_cmp_ne_u32 vcc, 1, v19
  s_nop 0
  s_and_b64 s[76:77], s[76:77], vcc
  v_cmp_ne_u32 vcc, 1, v20
  s_nop 0
  s_and_b64 s[78:79], s[78:79], vcc
  s_or_b64 vcc, s[40:41], s[42:43]
  s_or_b64 vcc, vcc, s[76:77]
  s_or_b64 vcc, vcc, s[78:79]
  s_cbranch_scc0 PA_32D
  s_sleep 4
  s_add_u32 s38, s38, 1
  s_cmp_lt_u32 s38, 60000
  s_cbranch_scc1 PA_32
PA_32D:
  s_mov_b32 s10, 0
DL_33:
  s_add_u32 m0, s10, 102400
  s_add_u32 s37, s10, s9
  s_add_u32 s37, s37, 0
  buffer_load_dwordx4 v12, s[28:31], s37 offen sc1 lds
  buffer_load_dwordx4 v12, s[28:31], s37 offen offset:1024 sc1 lds
  buffer_load_dwordx4 v12, s[28:31], s37 offen offset:2048 sc1 lds
  buffer_load_dwordx4 v12, s[28:31], s37 offen offset:3072 sc1 lds
  s_add_u32 s10, s10, 4096
  s_cmp_lt_u32 s10, 57344
  s_cbranch_scc1 DL_33
  s_waitcnt vmcnt(0)
  s_barrier
  s_setprio 2
  ds_read_b64_tr_b16 v[112:113], v10 offset:0
  ds_read_b64_tr_b16 v[114:115], v10 offset:1024
  ds_read_b64_tr_b16 v[116:117], v10 offset:32
  ds_read_b64_tr_b16 v[118:119], v10 offset:1056
  ds_read_b64_tr_b16 v[120:121], v10 offset:2048
  ds_read_b64_tr_b16 v[122:123], v10 offset:3072
  ds_read_b64_tr_b16 v[124:125], v10 offset:2080
  ds_read_b64_tr_b16 v[126:127], v10 offset:3104
  ds_read_b64_tr_b16 v[128:129], v10 offset:4096
  ds_read_b64_tr_b16 v[130:131], v10 offset:5120
  ds_read_b64_tr_b16 v[132:133], v10 offset:4128
  ds_read_b64_tr_b16 v[134:135], v10 offset:5152
  ds_read_b64_tr_b16 v[136:137], v10 offset:6144
  ds_read_b64_tr_b16 v[138:139], v10 offset:7168
  s_waitcnt lgkmcnt(12)
  v_mfma_f32_16x16x32_bf16 v[48:51], v[112:115], v[112:115], v[48:51]
  v_mfma_f32_16x16x32_bf16 v[52:55], v[40:43], v[112:115], v[52:55]
  ds_read_b64_tr_b16 v[140:141], v10 offset:6176
  ds_read_b64_tr_b16 v[142:143], v10 offset:7200
  s_waitcnt lgkmcnt(12)
  v_mfma_f32_16x16x32_bf16 v[56:59], v[116:119], v[116:119], v[56:59]
  v_mfma_f32_16x16x32_bf16 v[60:63], v[40:43], v[116:119], v[60:63]
  ds_read_b64_tr_b16 v[112:113], v10 offset:8192
  ds_read_b64_tr_b16 v[114:115], v10 offset:9216
  s_waitcnt lgkmcnt(12)
  v_mfma_f32_16x16x32_bf16 v[48:51], v[120:123], v[120:123], v[48:51]
  v_mfma_f32_16x16x32_bf16 v[52:55], v[40:43], v[120:123], v[52:55]
  ds_read_b64_tr_b16 v[116:117], v10 offset:8224
  ds_read_b64_tr_b16 v[118:119], v10 offset:9248
  s_waitcnt lgkmcnt(12)
  v_mfma_f32_16x16x32_bf16 v[56:59], v[124:127], v[124:127], v[56:59]
  v_mfma_f32_16x16x32_bf16 v[60:63], v[40:43], v[124:127], v[60:63]
  ds_read_b64_tr_b16 v[120:121], v10 offset:10240
  ds_read_b64_tr_b16 v[122:123], v10 offset:11264
  s_waitcnt lgkmcnt(12)
  v_mfma_f32_16x16x32_bf16 v[48:51], v[128:131], v[128:131], v[48:51]
  v_mfma_f32_16x16x32_bf16 v[52:55], v[40:43], v[128:131], v[52:55]
  ds_read_b64_tr_b16 v[124:125], v10 offset:10272
  ds_read_b64_tr_b16 v[126:127], v10 offset:11296
  s_waitcnt lgkmcnt(12)
  v_mfma_f32_16x16x32_bf16 v[56:59], v[132:135], v[132:135], v[56:59]
  v_mfma_f32_16x16x32_bf16 v[60:63], v[40:43], v[132:135], v[60:63]
  ds_read_b64_tr_b16 v[128:129], v10 offset:12288
  ds_read_b64_tr_b16 v[130:131], v10 offset:13312
  s_waitcnt lgkmcnt(12)
  v_mfma_f32_16x16x32_bf16 v[48:51], v[136:139], v[136:139], v[48:51]
  v_mfma_f32_16x16x32_bf16 v[52:55], v[40:43], v[136:139], v[52:55]
  ds_read_b64_tr_b16 v[132:133], v10 offset:12320
  ds_read_b64_tr_b16 v[134:135], v10 offset:13344
  s_waitcnt lgkmcnt(12)
  v_mfma_f32_16x16x32_bf16 v[56:59], v[140:143], v[140:143], v[56:59]
  v_mfma_f32_16x16x32_bf16 v[60:63], v[40:43], v[140:143], v[60:63]
  ds_read_b64_tr_b16 v[136:137], v10 offset:28672
  ds_read_b64_tr_b16 v[138:139], v10 offset:29696
  s_waitcnt lgkmcnt(12)
  v_mfma_f32_16x16x32_bf16 v[48:51], v[112:115], v[112:115], v[48:51]
  v_mfma_f32_16x16x32_bf16 v[52:55], v[40:43], v[112:115], v[52:55]
  ds_read_b64_tr_b16 v[140:141], v10 offset:28704
  ds_read_b64_tr_b16 v[142:143], v10 offset:29728
  s_waitcnt lgkmcnt(12)
  v_mfma_f32_16x16x32_bf16 v[56:59], v[116:119], v[116:119], v[56:59]
  v_mfma_f32_16x16x32_bf16 v[60:63], v[40:43], v[116:119], v[60:63]
  ds_read_b64_tr_b16 v[112:113], v10 offset:30720
  ds_read_b64_tr_b16 v[114:115], v10 offset:31744
  s_waitcnt lgkmcnt(12)
  v_mfma_f32_16x16x32_bf16 v[48:51], v[120:123], v[120:123], v[48:51]
  v_mfma_f32_16x16x32_bf16 v[52:55], v[40:43], v[120:123], v[52:55]
  ds_read_b64_tr_b16 v[116:117], v10 offset:30752
  ds_read_b64_tr_b16 v[118:119], v10 offset:31776
  s_waitcnt lgkmcnt(12)
  v_mfma_f32_16x16x32_bf16 v[56:59], v[124:127], v[124:127], v[56:59]
  v_mfma_f32_16x16x32_bf16 v[60:63], v[40:43], v[124:127], v[60:63]
  ds_read_b64_tr_b16 v[120:121], v10 offset:32768
  ds_read_b64_tr_b16 v[122:123], v10 offset:33792
  s_waitcnt lgkmcnt(12)
  v_mfma_f32_16x16x32_bf16 v[48:51], v[128:131], v[128:131], v[48:51]
  v_mfma_f32_16x16x32_bf16 v[52:55], v[40:43], v[128:131], v[52:55]
  ds_read_b64_tr_b16 v[124:125], v10 offset:32800
  ds_read_b64_tr_b16 v[126:127], v10 offset:33824
  s_waitcnt lgkmcnt(12)
  v_mfma_f32_16x16x32_bf16 v[56:59], v[132:135], v[132:135], v[56:59]
  v_mfma_f32_16x16x32_bf16 v[60:63], v[40:43], v[132:135], v[60:63]
  ds_read_b64_tr_b16 v[128:129], v10 offset:34816
  ds_read_b64_tr_b16 v[130:131], v10 offset:35840
  s_waitcnt lgkmcnt(12)
  v_mfma_f32_16x16x32_bf16 v[64:67], v[136:139], v[136:139], v[64:67]
  v_mfma_f32_16x16x32_bf16 v[68:71], v[40:43], v[136:139], v[68:71]
  ds_read_b64_tr_b16 v[132:133], v10 offset:34848
  ds_read_b64_tr_b16 v[134:135], v10 offset:35872
  s_waitcnt lgkmcnt(12)
  v_mfma_f32_16x16x32_bf16 v[72:75], v[140:143], v[140:143], v[72:75]
  v_mfma_f32_16x16x32_bf16 v[76:79], v[40:43], v[140:143], v[76:79]
  ds_read_b64_tr_b16 v[136:137], v10 offset:36864
  ds_read_b64_tr_b16 v[138:139], v10 offset:37888
  s_waitcnt lgkmcnt(12)
  v_mfma_f32_16x16x32_bf16 v[64:67], v[112:115], v[112:115], v[64:67]
  v_mfma_f32_16x16x32_bf16 v[68:71], v[40:43], v[112:115], v[68:71]
  ds_read_b64_tr_b16 v[140:141], v10 offset:36896
  ds_read_b64_tr_b16 v[142:143], v10 offset:37920
  s_waitcnt lgkmcnt(12)
  v_mfma_f32_16x16x32_bf16 v[72:75], v[116:119], v[116:119], v[72:75]
  v_mfma_f32_16x16x32_bf16 v[76:79], v[40:43], v[116:119], v[76:79]
  ds_read_b64_tr_b16 v[112:113], v10 offset:38912
  ds_read_b64_tr_b16 v[114:115], v10 offset:39936
  s_waitcnt lgkmcnt(12)
  v_mfma_f32_16x16x32_bf16 v[64:67], v[120:123], v[120:123], v[64:67]
  v_mfma_f32_16x16x32_bf16 v[68:71], v[40:43], v[120:123], v[68:71]
  ds_read_b64_tr_b16 v[116:117], v10 offset:38944
  ds_read_b64_tr_b16 v[118:119], v10 offset:39968
  s_waitcnt lgkmcnt(12)
  v_mfma_f32_16x16x32_bf16 v[72:75], v[124:127], v[124:127], v[72:75]
  v_mfma_f32_16x16x32_bf16 v[76:79], v[40:43], v[124:127], v[76:79]
  ds_read_b64_tr_b16 v[120:121], v10 offset:40960
  ds_read_b64_tr_b16 v[122:123], v10 offset:41984
  s_waitcnt lgkmcnt(12)
  v_mfma_f32_16x16x32_bf16 v[64:67], v[128:131], v[128:131], v[64:67]
  v_mfma_f32_16x16x32_bf16 v[68:71], v[40:43], v[128:131], v[68:71]
  ds_read_b64_tr_b16 v[124:125], v10 offset:40992
  ds_read_b64_tr_b16 v[126:127], v10 offset:42016
  s_waitcnt lgkmcnt(12)
  v_mfma_f32_16x16x32_bf16 v[72:75], v[132:135], v[132:135], v[72:75]
  v_mfma_f32_16x16x32_bf16 v[76:79], v[40:43], v[132:135], v[76:79]
  ds_read_b64_tr_b16 v[128:129], v10 offset:14336
  ds_read_b64_tr_b16 v[130:131], v10 offset:15360
  s_waitcnt lgkmcnt(12)
  v_mfma_f32_16x16x32_bf16 v[64:67], v[136:139], v[136:139], v[64:67]
  v_mfma_f32_16x16x32_bf16 v[68:71], v[40:43], v[136:139], v[68:71]
  ds_read_b64_tr_b16 v[132:133], v10 offset:14368
  ds_read_b64_tr_b16 v[134:135], v10 offset:15392
  s_waitcnt lgkmcnt(12)
  v_mfma_f32_16x16x32_bf16 v[72:75], v[140:143], v[140:143], v[72:75]
  v_mfma_f32_16x16x32_bf16 v[76:79], v[40:43], v[140:143], v[76:79]
  ds_read_b64_tr_b16 v[136:137], v10 offset:16384
  ds_read_b64_tr_b16 v[138:139], v10 offset:17408
  s_waitcnt lgkmcnt(12)
  v_mfma_f32_16x16x32_bf16 v[64:67], v[112:115], v[112:115], v[64:67]
  v_mfma_f32_16x16x32_bf16 v[68:71], v[40:43], v[112:115], v[68:71]
  ds_read_b64_tr_b16 v[140:141], v10 offset:16416
  ds_read_b64_tr_b16 v[142:143], v10 offset:17440
  s_waitcnt lgkmcnt(12)
  v_mfma_f32_16x16x32_bf16 v[72:75], v[116:119], v[116:119], v[72:75]
  v_mfma_f32_16x16x32_bf16 v[76:79], v[40:43], v[116:119], v[76:79]
  ds_read_b64_tr_b16 v[112:113], v10 offset:18432
  ds_read_b64_tr_b16 v[114:115], v10 offset:19456
  s_waitcnt lgkmcnt(12)
  v_mfma_f32_16x16x32_bf16 v[64:67], v[120:123], v[120:123], v[64:67]
  v_mfma_f32_16x16x32_bf16 v[68:71], v[40:43], v[120:123], v[68:71]
  ds_read_b64_tr_b16 v[116:117], v10 offset:18464
  ds_read_b64_tr_b16 v[118:119], v10 offset:19488
  s_waitcnt lgkmcnt(12)
  v_mfma_f32_16x16x32_bf16 v[72:75], v[124:127], v[124:127], v[72:75]
  v_mfma_f32_16x16x32_bf16 v[76:79], v[40:43], v[124:127], v[76:79]
  v_lshlrev_b32 v16, 6, v2
  s_mov_b32 s38, 0
  s_mov_b64 s[40:41], -1
  s_mov_b64 s[42:43], -1
  s_mov_b64 s[76:77], -1
  s_mov_b64 s[78:79], -1
PA_34:
  s_mov_b64 exec, s[40:41]
  s_cbranch_execz PA_34_0
  s_mov_b32 s39, 180224
  buffer_load_dword v17, v16, s[28:31], s39 offen sc1
PA_34_0:
  s_mov_b64 exec, s[42:43]
  s_cbranch_execz PA_34_1
  s_mov_b32 s39, 184320
  buffer_load_dword v18, v16, s[28:31], s39 offen sc1
PA_34_1:
  s_mov_b64 exec, s[76:77]
  s_cbranch_execz PA_34_2
  s_mov_b32 s39, 188416
  buffer_load_dword v19, v16, s[28:31], s39 offen sc1
PA_34_2:
  s_mov_b64 exec, s[78:79]
  s_cbranch_execz PA_34_3
  s_mov_b32 s39, 192512
  buffer_load_dword v20, v16, s[28:31], s39 offen sc1
PA_34_3:
  s_mov_b64 exec, -1
  s_waitcnt vmcnt(0)
  v_cmp_ne_u32 vcc, 1, v17
  s_nop 0
  s_and_b64 s[40:41], s[40:41], vcc
  v_cmp_ne_u32 vcc, 1, v18
  s_nop 0
  s_and_b64 s[42:43], s[42:43], vcc
  v_cmp_ne_u32 vcc, 1, v19
  s_nop 0
  s_and_b64 s[76:77], s[76:77], vcc
  v_cmp_ne_u32 vcc, 1, v20
  s_nop 0
  s_and_b64 s[78:79], s[78:79], vcc
  s_or_b64 vcc, s[40:41], s[42:43]
  s_or_b64 vcc, vcc, s[76:77]
  s_or_b64 vcc, vcc, s[78:79]
  s_cbranch_scc0 PA_34D
  s_sleep 4
  s_add_u32 s38, s38, 1
  s_cmp_lt_u32 s38, 60000
  s_cbranch_scc1 PA_34
PA_34D:
  s_barrier
  s_mov_b32 s10, 7168
  s_add_u32 s9, s9, s10
  s_add_u32 m0, s10, 0
  s_add_u32 s37, s9, 917504
  buffer_load_dwordx4 v12, s[28:31], s37 offen sc1 lds
  s_add_u32 m0, s10, 8192
  s_add_u32 s37, s9, 925696
  buffer_load_dwordx4 v12, s[28:31], s37 offen sc1 lds
  s_add_u32 m0, s10, 16384
  s_add_u32 s37, s9, 933888
  buffer_load_dwordx4 v12, s[28:31], s37 offen sc1 lds
  s_add_u32 m0, s10, 24576
  s_add_u32 s37, s9, 942080
  buffer_load_dwordx4 v12, s[28:31], s37 offen sc1 lds
  s_add_u32 m0, s10, 32768
  s_add_u32 s37, s9, 950272
  buffer_load_dwordx4 v12, s[28:31], s37 offen sc1 lds
  s_add_u32 m0, s10, 40960
  s_add_u32 s37, s9, 958464
  buffer_load_dwordx4 v12, s[28:31], s37 offen sc1 lds
  s_add_u32 m0, s10, 49152
  s_add_u32 s37, s9, 966656
  buffer_load_dwordx4 v12, s[28:31], s37 offen sc1 lds
  ds_read_b64_tr_b16 v[120:121], v10 offset:20480
  ds_read_b64_tr_b16 v[122:123], v10 offset:21504
  s_waitcnt lgkmcnt(12)
  v_mfma_f32_16x16x32_bf16 v[48:51], v[128:131], v[128:131], v[48:51]
  v_mfma_f32_16x16x32_bf16 v[52:55], v[40:43], v[128:131], v[52:55]
  ds_read_b64_tr_b16 v[124:125], v10 offset:20512
  ds_read_b64_tr_b16 v[126:127], v10 offset:21536
  s_waitcnt lgkmcnt(12)
  v_mfma_f32_16x16x32_bf16 v[56:59], v[132:135], v[132:135], v[56:59]
  v_mfma_f32_16x16x32_bf16 v[60:63], v[40:43], v[132:135], v[60:63]
  ds_read_b64_tr_b16 v[128:129], v10 offset:22528
  ds_read_b64_tr_b16 v[130:131], v10 offset:23552
  s_waitcnt lgkmcnt(12)
  v_mfma_f32_16x16x32_bf16 v[48:51], v[136:139], v[136:139], v[48:51]
  v_mfma_f32_16x16x32_bf16 v[52:55], v[40:43], v[136:139], v[52:55]
  ds_read_b64_tr_b16 v[132:133], v10 offset:22560
  ds_read_b64_tr_b16 v[134:135], v10 offset:23584
  s_waitcnt lgkmcnt(12)
  v_mfma_f32_16x16x32_bf16 v[56:59], v[140:143], v[140:143], v[56:59]
  v_mfma_f32_16x16x32_bf16 v[60:63], v[40:43], v[140:143], v[60:63]
  ds_read_b64_tr_b16 v[136:137], v10 offset:24576
  ds_read_b64_tr_b16 v[138:139], v10 offset:25600
  s_waitcnt lgkmcnt(12)
  v_mfma_f32_16x16x32_bf16 v[48:51], v[112:115], v[112:115], v[48:51]
  v_mfma_f32_16x16x32_bf16 v[52:55], v[40:43], v[112:115], v[52:55]
  ds_read_b64_tr_b16 v[140:141], v10 offset:24608
  ds_read_b64_tr_b16 v[142:143], v10 offset:25632
  s_waitcnt lgkmcnt(12)
  v_mfma_f32_16x16x32_bf16 v[56:59], v[116:119], v[116:119], v[56:59]
  v_mfma_f32_16x16x32_bf16 v[60:63], v[40:43], v[116:119], v[60:63]
  ds_read_b64_tr_b16 v[112:113], v10 offset:26624
  ds_read_b64_tr_b16 v[114:115], v10 offset:27648
  s_waitcnt lgkmcnt(12)
  v_mfma_f32_16x16x32_bf16 v[48:51], v[120:123], v[120:123], v[48:51]
  v_mfma_f32_16x16x32_bf16 v[52:55], v[40:43], v[120:123], v[52:55]
  ds_read_b64_tr_b16 v[116:117], v10 offset:26656
  ds_read_b64_tr_b16 v[118:119], v10 offset:27680
  s_waitcnt lgkmcnt(12)
  v_mfma_f32_16x16x32_bf16 v[56:59], v[124:127], v[124:127], v[56:59]
  v_mfma_f32_16x16x32_bf16 v[60:63], v[40:43], v[124:127], v[60:63]
  ds_read_b64_tr_b16 v[120:121], v10 offset:43008
  ds_read_b64_tr_b16 v[122:123], v10 offset:44032
  s_waitcnt lgkmcnt(12)
  v_mfma_f32_16x16x32_bf16 v[48:51], v[128:131], v[128:131], v[48:51]
  v_mfma_f32_16x16x32_bf16 v[52:55], v[40:43], v[128:131], v[52:55]
  ds_read_b64_tr_b16 v[124:125], v10 offset:43040
  ds_read_b64_tr_b16 v[126:127], v10 offset:44064
  s_waitcnt lgkmcnt(12)
  v_mfma_f32_16x16x32_bf16 v[56:59], v[132:135], v[132:135], v[56:59]
  v_mfma_f32_16x16x32_bf16 v[60:63], v[40:43], v[132:135], v[60:63]
  ds_read_b64_tr_b16 v[128:129], v10 offset:45056
  ds_read_b64_tr_b16 v[130:131], v10 offset:46080
  s_waitcnt lgkmcnt(12)
  v_mfma_f32_16x16x32_bf16 v[48:51], v[136:139], v[136:139], v[48:51]
  v_mfma_f32_16x16x32_bf16 v[52:55], v[40:43], v[136:139], v[52:55]
  ds_read_b64_tr_b16 v[132:133], v10 offset:45088
  ds_read_b64_tr_b16 v[134:135], v10 offset:46112
  s_waitcnt lgkmcnt(12)
  v_mfma_f32_16x16x32_bf16 v[56:59], v[140:143], v[140:143], v[56:59]
  v_mfma_f32_16x16x32_bf16 v[60:63], v[40:43], v[140:143], v[60:63]
  ds_read_b64_tr_b16 v[136:137], v10 offset:47104
  ds_read_b64_tr_b16 v[138:139], v10 offset:48128
  s_waitcnt lgkmcnt(12)
  v_mfma_f32_16x16x32_bf16 v[48:51], v[112:115], v[112:115], v[48:51]
  v_mfma_f32_16x16x32_bf16 v[52:55], v[40:43], v[112:115], v[52:55]
  ds_read_b64_tr_b16 v[140:141], v10 offset:47136
  ds_read_b64_tr_b16 v[142:143], v10 offset:48160
  s_waitcnt lgkmcnt(12)
  v_mfma_f32_16x16x32_bf16 v[56:59], v[116:119], v[116:119], v[56:59]
  v_mfma_f32_16x16x32_bf16 v[60:63], v[40:43], v[116:119], v[60:63]
  s_nop 2
  v_mul_f32 v16, 0x3b124925, v52
  v_cndmask_b32 v17, v48, v49, s[44:45]
  v_cndmask_b32 v17, v17, v50, s[46:47]
  v_cndmask_b32 v17, v17, v51, s[48:49]
  v_mul_f32 v17, 0x3b124925, v17
  v_fma_f32 v17, -v16, v16, v17
  v_max_f32 v17, 0, v17
  v_cvt_pk_bf16_f32 v18, -v16, -v16
  v_and_b32 v19, 0xffff, v18
  v_cvt_pk_bf16_f32 v17, v17, v17
  v_and_b32 v17, 0xffff0000, v17
  v_add_f32 v17, 0x3727c5ac, v17
  v_cvt_pk_bf16_f32 v17, v17, v17
  v_and_b32 v17, 0xffff0000, v17
  v_sqrt_f32 v17, v17
  s_nop 0
  v_cvt_pk_bf16_f32 v20, v17, v17
  v_and_b32 v21, 0xffff, v20
  v_and_b32 v17, 0xffff0000, v20
  v_rcp_f32 v22, v17
  v_mul_f32 v23, v17, v17
  v_mul_f32 v22, 0xbfb8aa3b, v22
  v_mul_f32 v24, 0x3b124925, v60
  v_cndmask_b32 v25, v56, v57, s[44:45]
  v_cndmask_b32 v25, v25, v58, s[46:47]
  v_cndmask_b32 v25, v25, v59, s[48:49]
  v_mul_f32 v25, 0x3b124925, v25
  v_fma_f32 v25, -v24, v24, v25
  v_max_f32 v25, 0, v25
  v_cvt_pk_bf16_f32 v26, -v24, -v24
  v_and_b32 v27, 0xffff, v26
  v_cvt_pk_bf16_f32 v25, v25, v25
  v_and_b32 v25, 0xffff0000, v25
  v_add_f32 v25, 0x3727c5ac, v25
  v_cvt_pk_bf16_f32 v25, v25, v25
  v_and_b32 v25, 0xffff0000, v25
  v_sqrt_f32 v25, v25
  s_nop 0
  v_cvt_pk_bf16_f32 v28, v25, v25
  v_and_b32 v29, 0xffff, v28
  v_and_b32 v25, 0xffff0000, v28
  v_rcp_f32 v30, v25
  v_mul_f32 v31, v25, v25
  v_mul_f32 v30, 0xbfb8aa3b, v30
  s_mov_b64 exec, s[50:51]
  ds_write_b64 v9, v[18:19] offset:0
  ds_write_b64 v9, v[20:21] offset:256
  ds_write_b64 v9, v[22:23] offset:512
  ds_write_b64 v9, v[26:27] offset:128
  ds_write_b64 v9, v[28:29] offset:384
  ds_write_b64 v9, v[30:31] offset:640
  s_mov_b64 exec, -1
  ds_read_b64_tr_b16 v[112:113], v10 offset:49152
  ds_read_b64_tr_b16 v[114:115], v10 offset:50176
  s_waitcnt lgkmcnt(15)
  v_mfma_f32_16x16x32_bf16 v[64:67], v[120:123], v[120:123], v[64:67]
  v_mfma_f32_16x16x32_bf16 v[68:71], v[40:43], v[120:123], v[68:71]
  ds_read_b64_tr_b16 v[116:117], v10 offset:49184
  ds_read_b64_tr_b16 v[118:119], v10 offset:50208
  v_mfma_f32_16x16x32_bf16 v[72:75], v[124:127], v[124:127], v[72:75]
  v_mfma_f32_16x16x32_bf16 v[76:79], v[40:43], v[124:127], v[76:79]
  ds_read_b64_tr_b16 v[120:121], v10 offset:51200
  ds_read_b64_tr_b16 v[122:123], v10 offset:52224
  s_waitcnt lgkmcnt(15)
  v_mfma_f32_16x16x32_bf16 v[64:67], v[128:131], v[128:131], v[64:67]
  v_mfma_f32_16x16x32_bf16 v[68:71], v[40:43], v[128:131], v[68:71]
  ds_read_b64_tr_b16 v[124:125], v10 offset:51232
  ds_read_b64_tr_b16 v[126:127], v10 offset:52256
  v_mfma_f32_16x16x32_bf16 v[72:75], v[132:135], v[132:135], v[72:75]
  v_mfma_f32_16x16x32_bf16 v[76:79], v[40:43], v[132:135], v[76:79]
  ds_read_b64_tr_b16 v[128:129], v10 offset:53248
  ds_read_b64_tr_b16 v[130:131], v10 offset:54272
  s_waitcnt lgkmcnt(15)
  v_mfma_f32_16x16x32_bf16 v[64:67], v[136:139], v[136:139], v[64:67]
  v_mfma_f32_16x16x32_bf16 v[68:71], v[40:43], v[136:139], v[68:71]
  ds_read_b64_tr_b16 v[132:133], v10 offset:53280
  ds_read_b64_tr_b16 v[134:135], v10 offset:54304
  v_mfma_f32_16x16x32_bf16 v[72:75], v[140:143], v[140:143], v[72:75]
  v_mfma_f32_16x16x32_bf16 v[76:79], v[40:43], v[140:143], v[76:79]
  ds_read_b64_tr_b16 v[136:137], v10 offset:55296
  ds_read_b64_tr_b16 v[138:139], v10 offset:56320
  s_waitcnt lgkmcnt(12)
  v_mfma_f32_16x16x32_bf16 v[64:67], v[112:115], v[112:115], v[64:67]
  v_mfma_f32_16x16x32_bf16 v[68:71], v[40:43], v[112:115], v[68:71]
  ds_read_b64_tr_b16 v[140:141], v10 offset:55328
  ds_read_b64_tr_b16 v[142:143], v10 offset:56352
  s_waitcnt lgkmcnt(12)
  v_mfma_f32_16x16x32_bf16 v[72:75], v[116:119], v[116:119], v[72:75]
  v_mfma_f32_16x16x32_bf16 v[76:79], v[40:43], v[116:119], v[76:79]
  s_waitcnt lgkmcnt(10)
  v_mfma_f32_16x16x32_bf16 v[64:67], v[120:123], v[120:123], v[64:67]
  v_mfma_f32_16x16x32_bf16 v[68:71], v[40:43], v[120:123], v[68:71]
  s_waitcnt lgkmcnt(8)
  v_mfma_f32_16x16x32_bf16 v[72:75], v[124:127], v[124:127], v[72:75]
  v_mfma_f32_16x16x32_bf16 v[76:79], v[40:43], v[124:127], v[76:79]
  s_waitcnt lgkmcnt(6)
  v_mfma_f32_16x16x32_bf16 v[64:67], v[128:131], v[128:131], v[64:67]
  v_mfma_f32_16x16x32_bf16 v[68:71], v[40:43], v[128:131], v[68:71]
  s_waitcnt lgkmcnt(4)
  v_mfma_f32_16x16x32_bf16 v[72:75], v[132:135], v[132:135], v[72:75]
  v_mfma_f32_16x16x32_bf16 v[76:79], v[40:43], v[132:135], v[76:79]
  s_waitcnt lgkmcnt(2)
  v_mfma_f32_16x16x32_bf16 v[64:67], v[136:139], v[136:139], v[64:67]
  v_mfma_f32_16x16x32_bf16 v[68:71], v[40:43], v[136:139], v[68:71]
  s_waitcnt lgkmcnt(0)
  v_mfma_f32_16x16x32_bf16 v[72:75], v[140:143], v[140:143], v[72:75]
  v_mfma_f32_16x16x32_bf16 v[76:79], v[40:43], v[140:143], v[76:79]
  s_nop 4
  v_mul_f32 v16, 0x3b124925, v68
  v_cndmask_b32 v17, v64, v65, s[44:45]
  v_cndmask_b32 v17, v17, v66, s[46:47]
  v_cndmask_b32 v17, v17, v67, s[48:49]
  v_mul_f32 v17, 0x3b124925, v17
  v_fma_f32 v17, -v16, v16, v17
  v_max_f32 v17, 0, v17
  v_cvt_pk_bf16_f32 v18, -v16, -v16
  v_and_b32 v19, 0xffff, v18
  v_cvt_pk_bf16_f32 v17, v17, v17
  v_and_b32 v17, 0xffff0000, v17
  v_add_f32 v17, 0x3727c5ac, v17
  v_cvt_pk_bf16_f32 v17, v17, v17
  v_and_b32 v17, 0xffff0000, v17
  v_sqrt_f32 v17, v17
  s_nop 0
  v_cvt_pk_bf16_f32 v20, v17, v17
  v_and_b32 v21, 0xffff, v20
  v_and_b32 v17, 0xffff0000, v20
  v_rcp_f32 v22, v17
  v_mul_f32 v23, v17, v17
  v_mul_f32 v22, 0xbfb8aa3b, v22
  v_mul_f32 v24, 0x3b124925, v76
  v_cndmask_b32 v25, v72, v73, s[44:45]
  v_cndmask_b32 v25, v25, v74, s[46:47]
  v_cndmask_b32 v25, v25, v75, s[48:49]
  v_mul_f32 v25, 0x3b124925, v25
  v_fma_f32 v25, -v24, v24, v25
  v_max_f32 v25, 0, v25
  v_cvt_pk_bf16_f32 v26, -v24, -v24
  v_and_b32 v27, 0xffff, v26
  v_cvt_pk_bf16_f32 v25, v25, v25
  v_and_b32 v25, 0xffff0000, v25
  v_add_f32 v25, 0x3727c5ac, v25
  v_cvt_pk_bf16_f32 v25, v25, v25
  v_and_b32 v25, 0xffff0000, v25
  v_sqrt_f32 v25, v25
  s_nop 0
  v_cvt_pk_bf16_f32 v28, v25, v25
  v_and_b32 v29, 0xffff, v28
  v_and_b32 v25, 0xffff0000, v28
  v_rcp_f32 v30, v25
  v_mul_f32 v31, v25, v25
  v_mul_f32 v30, 0xbfb8aa3b, v30
  s_mov_b64 exec, s[50:51]
  ds_write_b64 v9, v[18:19] offset:768
  ds_write_b64 v9, v[20:21] offset:1024
  ds_write_b64 v9, v[22:23] offset:1280
  ds_write_b64 v9, v[26:27] offset:896
  ds_write_b64 v9, v[28:29] offset:1152
  ds_write_b64 v9, v[30:31] offset:1408
  s_mov_b64 exec, -1
  s_waitcnt vmcnt(0)
  s_waitcnt lgkmcnt(0)
  s_barrier
  ds_read_b64_tr_b16 v[112:113], v11 offset:0
  ds_read_b64_tr_b16 v[114:115], v11 offset:1024
  ds_read_b64_tr_b16 v[116:117], v11 offset:32
  ds_read_b64_tr_b16 v[118:119], v11 offset:1056
  ds_read_b64_tr_b16 v[120:121], v11 offset:2048
  ds_read_b64_tr_b16 v[122:123], v11 offset:3072
  ds_read_b64_tr_b16 v[124:125], v11 offset:2080
  ds_read_b64_tr_b16 v[126:127], v11 offset:3104
  ds_read_b64_tr_b16 v[128:129], v11 offset:4096
  ds_read_b64_tr_b16 v[130:131], v11 offset:5120
  ds_read_b64_tr_b16 v[132:133], v11 offset:4128
  ds_read_b64_tr_b16 v[134:135], v11 offset:5152
  ds_read_b64_tr_b16 v[136:137], v11 offset:6144
  ds_read_b64_tr_b16 v[138:139], v11 offset:7168
  s_waitcnt lgkmcnt(12)
  v_mfma_f32_16x16x32_bf16 v[80:83], v[112:115], v[112:115], v[80:83]
  v_mfma_f32_16x16x32_bf16 v[84:87], v[40:43], v[112:115], v[84:87]
  s_add_u32 s37, s24, 0
  buffer_load_dwordx4 v[144:147], v12, s[28:31], s37 offen sc1
  ds_read_b64_tr_b16 v[140:141], v11 offset:6176
  ds_read_b64_tr_b16 v[142:143], v11 offset:7200
  s_waitcnt lgkmcnt(12)
  v_mfma_f32_16x16x32_bf16 v[88:91], v[116:119], v[116:119], v[88:91]
  v_mfma_f32_16x16x32_bf16 v[92:95], v[40:43], v[116:119], v[92:95]
  s_add_u32 s37, s24, 114688
  buffer_load_dwordx4 v[148:151], v12, s[28:31], s37 offen sc1
  ds_read_b64_tr_b16 v[112:113], v11 offset:8192
  ds_read_b64_tr_b16 v[114:115], v11 offset:9216
  s_waitcnt lgkmcnt(12)
  v_mfma_f32_16x16x32_bf16 v[80:83], v[120:123], v[120:123], v[80:83]
  v_mfma_f32_16x16x32_bf16 v[84:87], v[40:43], v[120:123], v[84:87]
  s_add_u32 s37, s24, 1024
  buffer_load_dwordx4 v[152:155], v12, s[28:31], s37 offen sc1
  ds_read_b64_tr_b16 v[116:117], v11 offset:8224
  ds_read_b64_tr_b16 v[118:119], v11 offset:9248
  s_waitcnt lgkmcnt(12)
  v_mfma_f32_16x16x32_bf16 v[88:91], v[124:127], v[124:127], v[88:91]
  v_mfma_f32_16x16x32_bf16 v[92:95], v[40:43], v[124:127], v[92:95]
  s_add_u32 s37, s24, 115712
  buffer_load_dwordx4 v[156:159], v12, s[28:31], s37 offen sc1
  ds_read_b64_tr_b16 v[120:121], v11 offset:10240
  ds_read_b64_tr_b16 v[122:123], v11 offset:11264
  s_waitcnt lgkmcnt(12)
  v_mfma_f32_16x16x32_bf16 v[80:83], v[128:131], v[128:131], v[80:83]
  v_mfma_f32_16x16x32_bf16 v[84:87], v[40:43], v[128:131], v[84:87]
  s_add_u32 s37, s24, 2048
  buffer_load_dwordx4 v[160:163], v12, s[28:31], s37 offen sc1
  s_barrier
  ds_read_b64_tr_b16 v[124:125], v11 offset:10272
  ds_read_b64_tr_b16 v[126:127], v11 offset:11296
  s_waitcnt lgkmcnt(12)
  v_mfma_f32_16x16x32_bf16 v[88:91], v[132:135], v[132:135], v[88:91]
  v_mfma_f32_16x16x32_bf16 v[92:95], v[40:43], v[132:135], v[92:95]
  s_add_u32 s37, s24, 116736
  buffer_load_dwordx4 v[164:167], v12, s[28:31], s37 offen sc1
  ds_read_b64_tr_b16 v[128:129], v11 offset:12288
  ds_read_b64_tr_b16 v[130:131], v11 offset:13312
  s_waitcnt lgkmcnt(12)
  v_mfma_f32_16x16x32_bf16 v[80:83], v[136:139], v[136:139], v[80:83]
  v_mfma_f32_16x16x32_bf16 v[84:87], v[40:43], v[136:139], v[84:87]
  s_add_u32 s37, s24, 3072
  buffer_load_dwordx4 v[168:171], v12, s[28:31], s37 offen sc1
  ds_read_b64_tr_b16 v[132:133], v11 offset:12320
  ds_read_b64_tr_b16 v[134:135], v11 offset:13344
  s_waitcnt lgkmcnt(12)
  v_mfma_f32_16x16x32_bf16 v[88:91], v[140:143], v[140:143], v[88:91]
  v_mfma_f32_16x16x32_bf16 v[92:95], v[40:43], v[140:143], v[92:95]
  s_add_u32 s37, s24, 117760
  buffer_load_dwordx4 v[172:175], v12, s[28:31], s37 offen sc1
  ds_read_b64_tr_b16 v[136:137], v11 offset:28672
  ds_read_b64_tr_b16 v[138:139], v11 offset:29696
  s_waitcnt lgkmcnt(12)
  v_mfma_f32_16x16x32_bf16 v[80:83], v[112:115], v[112:115], v[80:83]
  v_mfma_f32_16x16x32_bf16 v[84:87], v[40:43], v[112:115], v[84:87]
  s_add_u32 s37, s24, 4096
  buffer_load_dwordx4 v[176:179], v12, s[28:31], s37 offen sc1
  ds_read_b64_tr_b16 v[140:141], v11 offset:28704
  ds_read_b64_tr_b16 v[142:143], v11 offset:29728
  s_waitcnt lgkmcnt(12)
  v_mfma_f32_16x16x32_bf16 v[88:91], v[116:119], v[116:119], v[88:91]
  v_mfma_f32_16x16x32_bf16 v[92:95], v[40:43], v[116:119], v[92:95]
  s_add_u32 s37, s24, 118784
  buffer_load_dwordx4 v[180:183], v12, s[28:31], s37 offen sc1
  ds_read_b64_tr_b16 v[112:113], v11 offset:30720
  ds_read_b64_tr_b16 v[114:115], v11 offset:31744
  s_waitcnt lgkmcnt(12)
  v_mfma_f32_16x16x32_bf16 v[80:83], v[120:123], v[120:123], v[80:83]
  v_mfma_f32_16x16x32_bf16 v[84:87], v[40:43], v[120:123], v[84:87]
  s_add_u32 s37, s24, 5120
  buffer_load_dwordx4 v[184:187], v12, s[28:31], s37 offen sc1
  ds_read_b64_tr_b16 v[116:117], v11 offset:30752
  ds_read_b64_tr_b16 v[118:119], v11 offset:31776
  s_waitcnt lgkmcnt(12)
  v_mfma_f32_16x16x32_bf16 v[88:91], v[124:127], v[124:127], v[88:91]
  v_mfma_f32_16x16x32_bf16 v[92:95], v[40:43], v[124:127], v[92:95]
  s_add_u32 s37, s24, 119808
  buffer_load_dwordx4 v[188:191], v12, s[28:31], s37 offen sc1
  ds_read_b64_tr_b16 v[120:121], v11 offset:32768
  ds_read_b64_tr_b16 v[122:123], v11 offset:33792
  s_waitcnt lgkmcnt(12)
  v_mfma_f32_16x16x32_bf16 v[80:83], v[128:131], v[128:131], v[80:83]
  v_mfma_f32_16x16x32_bf16 v[84:87], v[40:43], v[128:131], v[84:87]
  s_add_u32 s37, s24, 6144
  buffer_load_dwordx4 v[192:195], v12, s[28:31], s37 offen sc1
  ds_read_b64_tr_b16 v[124:125], v11 offset:32800
  ds_read_b64_tr_b16 v[126:127], v11 offset:33824
  s_waitcnt lgkmcnt(12)
  v_mfma_f32_16x16x32_bf16 v[88:91], v[132:135], v[132:135], v[88:91]
  v_mfma_f32_16x16x32_bf16 v[92:95], v[40:43], v[132:135], v[92:95]
  s_add_u32 s37, s24, 120832
  buffer_load_dwordx4 v[196:199], v12, s[28:31], s37 offen sc1
  ds_read_b64_tr_b16 v[128:129], v11 offset:34816
  ds_read_b64_tr_b16 v[130:131], v11 offset:35840
  s_waitcnt lgkmcnt(12)
  v_mfma_f32_16x16x32_bf16 v[96:99], v[136:139], v[136:139], v[96:99]
  v_mfma_f32_16x16x32_bf16 v[100:103], v[40:43], v[136:139], v[100:103]
  s_add_u32 s37, s24, 7168
  buffer_load_dwordx4 v[200:203], v12, s[28:31], s37 offen sc1
  ds_read_b64_tr_b16 v[132:133], v11 offset:34848
  ds_read_b64_tr_b16 v[134:135], v11 offset:35872
  s_waitcnt lgkmcnt(12)
  v_mfma_f32_16x16x32_bf16 v[104:107], v[140:143], v[140:143], v[104:107]
  v_mfma_f32_16x16x32_bf16 v[108:111], v[40:43], v[140:143], v[108:111]
  s_add_u32 s37, s24, 121856
  buffer_load_dwordx4 v[204:207], v12, s[28:31], s37 offen sc1
  ds_read_b64_tr_b16 v[136:137], v11 offset:36864
  ds_read_b64_tr_b16 v[138:139], v11 offset:37888
  s_waitcnt lgkmcnt(12)
  v_mfma_f32_16x16x32_bf16 v[96:99], v[112:115], v[112:115], v[96:99]
  v_mfma_f32_16x16x32_bf16 v[100:103], v[40:43], v[112:115], v[100:103]
  s_add_u32 s37, s24, 8192
  buffer_load_dwordx4 v[208:211], v12, s[28:31], s37 offen sc1
  ds_read_b64_tr_b16 v[140:141], v11 offset:36896
  ds_read_b64_tr_b16 v[142:143], v11 offset:37920
  s_waitcnt lgkmcnt(12)
  v_mfma_f32_16x16x32_bf16 v[104:107], v[116:119], v[116:119], v[104:107]
  v_mfma_f32_16x16x32_bf16 v[108:111], v[40:43], v[116:119], v[108:111]
  s_add_u32 s37, s24, 122880
  buffer_load_dwordx4 v[212:215], v12, s[28:31], s37 offen sc1
  ds_read_b64_tr_b16 v[112:113], v11 offset:38912
  ds_read_b64_tr_b16 v[114:115], v11 offset:39936
  s_waitcnt lgkmcnt(12)
  v_mfma_f32_16x16x32_bf16 v[96:99], v[120:123], v[120:123], v[96:99]
  v_mfma_f32_16x16x32_bf16 v[100:103], v[40:43], v[120:123], v[100:103]
  s_add_u32 s37, s24, 9216
  buffer_load_dwordx4 v[216:219], v12, s[28:31], s37 offen sc1
  ds_read_b64_tr_b16 v[116:117], v11 offset:38944
  ds_read_b64_tr_b16 v[118:119], v11 offset:39968
  s_waitcnt lgkmcnt(12)
  v_mfma_f32_16x16x32_bf16 v[104:107], v[124:127], v[124:127], v[104:107]
  v_mfma_f32_16x16x32_bf16 v[108:111], v[40:43], v[124:127], v[108:111]
  s_add_u32 s37, s24, 123904
  buffer_load_dwordx4 v[220:223], v12, s[28:31], s37 offen sc1
  ds_read_b64_tr_b16 v[120:121], v11 offset:40960
  ds_read_b64_tr_b16 v[122:123], v11 offset:41984
  s_waitcnt lgkmcnt(12)
  v_mfma_f32_16x16x32_bf16 v[96:99], v[128:131], v[128:131], v[96:99]
  v_mfma_f32_16x16x32_bf16 v[100:103], v[40:43], v[128:131], v[100:103]
  s_add_u32 s37, s24, 10240
  buffer_load_dwordx4 v[224:227], v12, s[28:31], s37 offen sc1
  ds_read_b64_tr_b16 v[124:125], v11 offset:40992
  ds_read_b64_tr_b16 v[126:127], v11 offset:42016
  s_waitcnt lgkmcnt(12)
  v_mfma_f32_16x16x32_bf16 v[104:107], v[132:135], v[132:135], v[104:107]
  v_mfma_f32_16x16x32_bf16 v[108:111], v[40:43], v[132:135], v[108:111]
  s_add_u32 s37, s24, 124928
  buffer_load_dwordx4 v[228:231], v12, s[28:31], s37 offen sc1
  ds_read_b64_tr_b16 v[128:129], v11 offset:14336
  ds_read_b64_tr_b16 v[130:131], v11 offset:15360
  s_waitcnt lgkmcnt(12)
  v_mfma_f32_16x16x32_bf16 v[96:99], v[136:139], v[136:139], v[96:99]
  v_mfma_f32_16x16x32_bf16 v[100:103], v[40:43], v[136:139], v[100:103]
  s_add_u32 s37, s24, 11264
  buffer_load_dwordx4 v[232:235], v12, s[28:31], s37 offen sc1
  ds_read_b64_tr_b16 v[132:133], v11 offset:14368
  ds_read_b64_tr_b16 v[134:135], v11 offset:15392
  s_waitcnt lgkmcnt(12)
  v_mfma_f32_16x16x32_bf16 v[104:107], v[140:143], v[140:143], v[104:107]
  v_mfma_f32_16x16x32_bf16 v[108:111], v[40:43], v[140:143], v[108:111]
  s_add_u32 s37, s24, 125952
  buffer_load_dwordx4 v[236:239], v12, s[28:31], s37 offen sc1
  ds_read_b64_tr_b16 v[136:137], v11 offset:16384
  ds_read_b64_tr_b16 v[138:139], v11 offset:17408
  s_waitcnt lgkmcnt(12)
  v_mfma_f32_16x16x32_bf16 v[96:99], v[112:115], v[112:115], v[96:99]
  v_mfma_f32_16x16x32_bf16 v[100:103], v[40:43], v[112:115], v[100:103]
  s_add_u32 s37, s24, 12288
  buffer_load_dwordx4 v[240:243], v12, s[28:31], s37 offen sc1
  ds_read_b64_tr_b16 v[140:141], v11 offset:16416
  ds_read_b64_tr_b16 v[142:143], v11 offset:17440
  s_waitcnt lgkmcnt(12)
  v_mfma_f32_16x16x32_bf16 v[104:107], v[116:119], v[116:119], v[104:107]
  v_mfma_f32_16x16x32_bf16 v[108:111], v[40:43], v[116:119], v[108:111]
  s_add_u32 s37, s24, 126976
  buffer_load_dwordx4 v[244:247], v12, s[28:31], s37 offen sc1
  ds_read_b64_tr_b16 v[112:113], v11 offset:18432
  ds_read_b64_tr_b16 v[114:115], v11 offset:19456
  s_waitcnt lgkmcnt(12)
  v_mfma_f32_16x16x32_bf16 v[96:99], v[120:123], v[120:123], v[96:99]
  v_mfma_f32_16x16x32_bf16 v[100:103], v[40:43], v[120:123], v[100:103]
  s_add_u32 s37, s24, 13312
  buffer_load_dwordx4 v[248:251], v12, s[28:31], s37 offen sc1
  ds_read_b64_tr_b16 v[116:117], v11 offset:18464
  ds_read_b64_tr_b16 v[118:119], v11 offset:19488
  s_waitcnt lgkmcnt(12)
  v_mfma_f32_16x16x32_bf16 v[104:107], v[124:127], v[124:127], v[104:107]
  v_mfma_f32_16x16x32_bf16 v[108:111], v[40:43], v[124:127], v[108:111]
  s_add_u32 s37, s24, 128000
  buffer_load_dwordx4 v[252:255], v12, s[28:31], s37 offen sc1
  ds_read_b64_tr_b16 v[120:121], v11 offset:20480
  ds_read_b64_tr_b16 v[122:123], v11 offset:21504
  s_waitcnt lgkmcnt(12)
  v_mfma_f32_16x16x32_bf16 v[80:83], v[128:131], v[128:131], v[80:83]
  v_mfma_f32_16x16x32_bf16 v[84:87], v[40:43], v[128:131], v[84:87]
  ds_read_b64_tr_b16 v[124:125], v11 offset:20512
  ds_read_b64_tr_b16 v[126:127], v11 offset:21536
  s_waitcnt lgkmcnt(12)
  v_mfma_f32_16x16x32_bf16 v[88:91], v[132:135], v[132:135], v[88:91]
  v_mfma_f32_16x16x32_bf16 v[92:95], v[40:43], v[132:135], v[92:95]
  ds_read_b64_tr_b16 v[128:129], v11 offset:22528
  ds_read_b64_tr_b16 v[130:131], v11 offset:23552
  s_waitcnt lgkmcnt(12)
  v_mfma_f32_16x16x32_bf16 v[80:83], v[136:139], v[136:139], v[80:83]
  v_mfma_f32_16x16x32_bf16 v[84:87], v[40:43], v[136:139], v[84:87]
  ds_read_b64_tr_b16 v[132:133], v11 offset:22560
  ds_read_b64_tr_b16 v[134:135], v11 offset:23584
  s_waitcnt lgkmcnt(12)
  v_mfma_f32_16x16x32_bf16 v[88:91], v[140:143], v[140:143], v[88:91]
  v_mfma_f32_16x16x32_bf16 v[92:95], v[40:43], v[140:143], v[92:95]
  ds_read_b64_tr_b16 v[136:137], v11 offset:24576
  ds_read_b64_tr_b16 v[138:139], v11 offset:25600
  s_waitcnt lgkmcnt(12)
  v_mfma_f32_16x16x32_bf16 v[80:83], v[112:115], v[112:115], v[80:83]
  v_mfma_f32_16x16x32_bf16 v[84:87], v[40:43], v[112:115], v[84:87]
  ds_read_b64_tr_b16 v[140:141], v11 offset:24608
  ds_read_b64_tr_b16 v[142:143], v11 offset:25632
  s_waitcnt lgkmcnt(12)
  v_mfma_f32_16x16x32_bf16 v[88:91], v[116:119], v[116:119], v[88:91]
  v_mfma_f32_16x16x32_bf16 v[92:95], v[40:43], v[116:119], v[92:95]
  ds_read_b64_tr_b16 v[112:113], v11 offset:26624
  ds_read_b64_tr_b16 v[114:115], v11 offset:27648
  s_waitcnt lgkmcnt(12)
  v_mfma_f32_16x16x32_bf16 v[80:83], v[120:123], v[120:123], v[80:83]
  v_mfma_f32_16x16x32_bf16 v[84:87], v[40:43], v[120:123], v[84:87]
  ds_read_b64_tr_b16 v[116:117], v11 offset:26656
  ds_read_b64_tr_b16 v[118:119], v11 offset:27680
  s_waitcnt lgkmcnt(12)
  v_mfma_f32_16x16x32_bf16 v[88:91], v[124:127], v[124:127], v[88:91]
  v_mfma_f32_16x16x32_bf16 v[92:95], v[40:43], v[124:127], v[92:95]
  ds_read_b64_tr_b16 v[120:121], v11 offset:43008
  ds_read_b64_tr_b16 v[122:123], v11 offset:44032
  s_waitcnt lgkmcnt(12)
  v_mfma_f32_16x16x32_bf16 v[80:83], v[128:131], v[128:131], v[80:83]
  v_mfma_f32_16x16x32_bf16 v[84:87], v[40:43], v[128:131], v[84:87]
  ds_read_b64_tr_b16 v[124:125], v11 offset:43040
  ds_read_b64_tr_b16 v[126:127], v11 offset:44064
  s_waitcnt lgkmcnt(12)
  v_mfma_f32_16x16x32_bf16 v[88:91], v[132:135], v[132:135], v[88:91]
  v_mfma_f32_16x16x32_bf16 v[92:95], v[40:43], v[132:135], v[92:95]
  ds_read_b64_tr_b16 v[128:129], v11 offset:45056
  ds_read_b64_tr_b16 v[130:131], v11 offset:46080
  s_waitcnt lgkmcnt(12)
  v_mfma_f32_16x16x32_bf16 v[80:83], v[136:139], v[136:139], v[80:83]
  v_mfma_f32_16x16x32_bf16 v[84:87], v[40:43], v[136:139], v[84:87]
  ds_read_b64_tr_b16 v[132:133], v11 offset:45088
  ds_read_b64_tr_b16 v[134:135], v11 offset:46112
  s_waitcnt lgkmcnt(12)
  v_mfma_f32_16x16x32_bf16 v[88:91], v[140:143], v[140:143], v[88:91]
  v_mfma_f32_16x16x32_bf16 v[92:95], v[40:43], v[140:143], v[92:95]
  ds_read_b64_tr_b16 v[136:137], v11 offset:47104
  ds_read_b64_tr_b16 v[138:139], v11 offset:48128
  s_waitcnt lgkmcnt(12)
  v_mfma_f32_16x16x32_bf16 v[80:83], v[112:115], v[112:115], v[80:83]
  v_mfma_f32_16x16x32_bf16 v[84:87], v[40:43], v[112:115], v[84:87]
  ds_read_b64_tr_b16 v[140:141], v11 offset:47136
  ds_read_b64_tr_b16 v[142:143], v11 offset:48160
  s_waitcnt lgkmcnt(12)
  v_mfma_f32_16x16x32_bf16 v[88:91], v[116:119], v[116:119], v[88:91]
  v_mfma_f32_16x16x32_bf16 v[92:95], v[40:43], v[116:119], v[92:95]
  s_nop 2
  v_mul_f32 v16, 0x3b124925, v84
  v_cndmask_b32 v17, v80, v81, s[44:45]
  v_cndmask_b32 v17, v17, v82, s[46:47]
  v_cndmask_b32 v17, v17, v83, s[48:49]
  v_mul_f32 v17, 0x3b124925, v17
  v_fma_f32 v17, -v16, v16, v17
  v_max_f32 v17, 0, v17
  v_cvt_pk_bf16_f32 v18, -v16, -v16
  v_and_b32 v19, 0xffff, v18
  v_cvt_pk_bf16_f32 v17, v17, v17
  v_and_b32 v17, 0xffff0000, v17
  v_add_f32 v17, 0x3727c5ac, v17
  v_cvt_pk_bf16_f32 v17, v17, v17
  v_and_b32 v17, 0xffff0000, v17
  v_sqrt_f32 v17, v17
  s_nop 0
  v_cvt_pk_bf16_f32 v20, v17, v17
  v_and_b32 v21, 0xffff, v20
  v_and_b32 v17, 0xffff0000, v20
  v_rcp_f32 v22, v17
  v_mul_f32 v23, v17, v17
  v_mul_f32 v22, 0xbfb8aa3b, v22
  v_mul_f32 v24, 0x3b124925, v92
  v_cndmask_b32 v25, v88, v89, s[44:45]
  v_cndmask_b32 v25, v25, v90, s[46:47]
  v_cndmask_b32 v25, v25, v91, s[48:49]
  v_mul_f32 v25, 0x3b124925, v25
  v_fma_f32 v25, -v24, v24, v25
  v_max_f32 v25, 0, v25
  v_cvt_pk_bf16_f32 v26, -v24, -v24
  v_and_b32 v27, 0xffff, v26
  v_cvt_pk_bf16_f32 v25, v25, v25
  v_and_b32 v25, 0xffff0000, v25
  v_add_f32 v25, 0x3727c5ac, v25
  v_cvt_pk_bf16_f32 v25, v25, v25
  v_and_b32 v25, 0xffff0000, v25
  v_sqrt_f32 v25, v25
  s_nop 0
  v_cvt_pk_bf16_f32 v28, v25, v25
  v_and_b32 v29, 0xffff, v28
  v_and_b32 v25, 0xffff0000, v28
  v_rcp_f32 v30, v25
  v_mul_f32 v31, v25, v25
  v_mul_f32 v30, 0xbfb8aa3b, v30
  s_mov_b64 exec, s[50:51]
  ds_write_b64 v9, v[18:19] offset:1536
  ds_write_b64 v9, v[20:21] offset:1792
  ds_write_b64 v9, v[22:23] offset:2048
  ds_write_b64 v9, v[26:27] offset:1664
  ds_write_b64 v9, v[28:29] offset:1920
  ds_write_b64 v9, v[30:31] offset:2176
  s_mov_b64 exec, -1
  s_waitcnt lgkmcnt(0)
  s_barrier
  s_mov_b64 exec, 1
  s_lshl_b32 s37, s2, 6
  s_add_u32 s37, s37, 212992
  v_mov_b32 v16, 0
  v_mov_b32 v17, 1
  buffer_store_dword v17, v16, s[28:31], s37 offen sc1
  s_mov_b64 exec, -1
  ds_read_b64_tr_b16 v[112:113], v11 offset:49152
  ds_read_b64_tr_b16 v[114:115], v11 offset:50176
  v_mfma_f32_16x16x32_bf16 v[96:99], v[120:123], v[120:123], v[96:99]
  v_mfma_f32_16x16x32_bf16 v[100:103], v[40:43], v[120:123], v[100:103]
  ds_read_b64_tr_b16 v[116:117], v11 offset:49184
  ds_read_b64_tr_b16 v[118:119], v11 offset:50208
  v_mfma_f32_16x16x32_bf16 v[104:107], v[124:127], v[124:127], v[104:107]
  v_mfma_f32_16x16x32_bf16 v[108:111], v[40:43], v[124:127], v[108:111]
  ds_read_b64_tr_b16 v[120:121], v11 offset:51200
  ds_read_b64_tr_b16 v[122:123], v11 offset:52224
  v_mfma_f32_16x16x32_bf16 v[96:99], v[128:131], v[128:131], v[96:99]
  v_mfma_f32_16x16x32_bf16 v[100:103], v[40:43], v[128:131], v[100:103]
  ds_read_b64_tr_b16 v[124:125], v11 offset:51232
  ds_read_b64_tr_b16 v[126:127], v11 offset:52256
  v_mfma_f32_16x16x32_bf16 v[104:107], v[132:135], v[132:135], v[104:107]
  v_mfma_f32_16x16x32_bf16 v[108:111], v[40:43], v[132:135], v[108:111]
  ds_read_b64_tr_b16 v[128:129], v11 offset:53248
  ds_read_b64_tr_b16 v[130:131], v11 offset:54272
  v_mfma_f32_16x16x32_bf16 v[96:99], v[136:139], v[136:139], v[96:99]
  v_mfma_f32_16x16x32_bf16 v[100:103], v[40:43], v[136:139], v[100:103]
  ds_read_b64_tr_b16 v[132:133], v11 offset:53280
  ds_read_b64_tr_b16 v[134:135], v11 offset:54304
  v_mfma_f32_16x16x32_bf16 v[104:107], v[140:143], v[140:143], v[104:107]
  v_mfma_f32_16x16x32_bf16 v[108:111], v[40:43], v[140:143], v[108:111]
  ds_read_b64_tr_b16 v[136:137], v11 offset:55296
  ds_read_b64_tr_b16 v[138:139], v11 offset:56320
  s_waitcnt lgkmcnt(12)
  v_mfma_f32_16x16x32_bf16 v[96:99], v[112:115], v[112:115], v[96:99]
  v_mfma_f32_16x16x32_bf16 v[100:103], v[40:43], v[112:115], v[100:103]
  ds_read_b64_tr_b16 v[140:141], v11 offset:55328
  ds_read_b64_tr_b16 v[142:143], v11 offset:56352
  s_waitcnt lgkmcnt(12)
  v_mfma_f32_16x16x32_bf16 v[104:107], v[116:119], v[116:119], v[104:107]
  v_mfma_f32_16x16x32_bf16 v[108:111], v[40:43], v[116:119], v[108:111]
  s_waitcnt lgkmcnt(10)
  v_mfma_f32_16x16x32_bf16 v[96:99], v[120:123], v[120:123], v[96:99]
  v_mfma_f32_16x16x32_bf16 v[100:103], v[40:43], v[120:123], v[100:103]
  s_waitcnt lgkmcnt(8)
  v_mfma_f32_16x16x32_bf16 v[104:107], v[124:127], v[124:127], v[104:107]
  v_mfma_f32_16x16x32_bf16 v[108:111], v[40:43], v[124:127], v[108:111]
  s_waitcnt lgkmcnt(6)
  v_mfma_f32_16x16x32_bf16 v[96:99], v[128:131], v[128:131], v[96:99]
  v_mfma_f32_16x16x32_bf16 v[100:103], v[40:43], v[128:131], v[100:103]
  s_waitcnt lgkmcnt(4)
  v_mfma_f32_16x16x32_bf16 v[104:107], v[132:135], v[132:135], v[104:107]
  v_mfma_f32_16x16x32_bf16 v[108:111], v[40:43], v[132:135], v[108:111]
  s_waitcnt lgkmcnt(2)
  v_mfma_f32_16x16x32_bf16 v[96:99], v[136:139], v[136:139], v[96:99]
  v_mfma_f32_16x16x32_bf16 v[100:103], v[40:43], v[136:139], v[100:103]
  s_waitcnt lgkmcnt(0)
  v_mfma_f32_16x16x32_bf16 v[104:107], v[140:143], v[140:143], v[104:107]
  v_mfma_f32_16x16x32_bf16 v[108:111], v[40:43], v[140:143], v[108:111]
  s_nop 4
  v_mul_f32 v16, 0x3b124925, v100
  v_cndmask_b32 v17, v96, v97, s[44:45]
  v_cndmask_b32 v17, v17, v98, s[46:47]
  v_cndmask_b32 v17, v17, v99, s[48:49]
  v_mul_f32 v17, 0x3b124925, v17
  v_fma_f32 v17, -v16, v16, v17
  v_max_f32 v17, 0, v17
  v_cvt_pk_bf16_f32 v18, -v16, -v16
  v_and_b32 v19, 0xffff, v18
  v_cvt_pk_bf16_f32 v17, v17, v17
  v_and_b32 v17, 0xffff0000, v17
  v_add_f32 v17, 0x3727c5ac, v17
  v_cvt_pk_bf16_f32 v17, v17, v17
  v_and_b32 v17, 0xffff0000, v17
  v_sqrt_f32 v17, v17
  s_nop 0
  v_cvt_pk_bf16_f32 v20, v17, v17
  v_and_b32 v21, 0xffff, v20
  v_and_b32 v17, 0xffff0000, v20
  v_rcp_f32 v22, v17
  v_mul_f32 v23, v17, v17
  v_mul_f32 v22, 0xbfb8aa3b, v22
  v_mul_f32 v24, 0x3b124925, v108
  v_cndmask_b32 v25, v104, v105, s[44:45]
  v_cndmask_b32 v25, v25, v106, s[46:47]
  v_cndmask_b32 v25, v25, v107, s[48:49]
  v_mul_f32 v25, 0x3b124925, v25
  v_fma_f32 v25, -v24, v24, v25
  v_max_f32 v25, 0, v25
  v_cvt_pk_bf16_f32 v26, -v24, -v24
  v_and_b32 v27, 0xffff, v26
  v_cvt_pk_bf16_f32 v25, v25, v25
  v_and_b32 v25, 0xffff0000, v25
  v_add_f32 v25, 0x3727c5ac, v25
  v_cvt_pk_bf16_f32 v25, v25, v25
  v_and_b32 v25, 0xffff0000, v25
  v_sqrt_f32 v25, v25
  s_nop 0
  v_cvt_pk_bf16_f32 v28, v25, v25
  v_and_b32 v29, 0xffff, v28
  v_and_b32 v25, 0xffff0000, v28
  v_rcp_f32 v30, v25
  v_mul_f32 v31, v25, v25
  v_mul_f32 v30, 0xbfb8aa3b, v30
  s_mov_b64 exec, s[50:51]
  ds_write_b64 v9, v[18:19] offset:2304
  ds_write_b64 v9, v[20:21] offset:2560
  ds_write_b64 v9, v[22:23] offset:2816
  ds_write_b64 v9, v[26:27] offset:2432
  ds_write_b64 v9, v[28:29] offset:2688
  ds_write_b64 v9, v[30:31] offset:2944
  s_mov_b64 exec, -1
  s_waitcnt lgkmcnt(0)
  s_barrier
  s_setprio 0
D_ENTRY:
  s_lshr_b32 s25, s20, 1
  v_and_b32 v6, 1, v2
  s_lshl_b32 s37, s22, 1
  v_add_u32 v6, s37, v6
  v_and_b32 v7, 3, v6
  v_lshlrev_b32 v7, 3, v7
  s_and_b32 s37, s25, 7
  v_add_u32 v7, s37, v7
  v_lshlrev_b32 v7, 3, v7
  v_lshrrev_b32 v6, 2, v6
  v_add_u32 v7, v7, v6
  s_lshr_b32 s37, s25, 3
  s_lshl_b32 s37, s37, 2
  v_add_u32 v7, s37, v7
  v_lshlrev_b32 v7, 6, v7
  s_mov_b32 s17, s20
  s_mul_i32 s11, s17, 114688
  s_add_u32 s11, s11, s23
  s_add_u32 s11, s11, 16777216
  s_cmp_eq_u32 s3, 7
  s_cbranch_scc1 D_NOARR
  s_waitcnt vmcnt(0) lgkmcnt(0)
  s_mov_b64 exec, 1
  v_mov_b32 v36, 159752
  v_mov_b32 v37, 1
  ds_add_rtn_u32 v38, v36, v37
  s_waitcnt lgkmcnt(0)
  v_readfirstlane_b32 s37, v38
  s_nop 0
  s_cmp_lg_u32 s37, 6
  s_cbranch_scc1 ARR_35
  s_lshl_b32 s37, s2, 6
  s_add_u32 s37, s37, 196608
  v_mov_b32 v36, 0
  v_mov_b32 v37, 1
  buffer_store_dword v37, v36, s[28:31], s37 offen sc1
ARR_35:
  s_mov_b64 exec, -1
D_NOARR:
  s_cmp_ge_u32 s2, 224
  s_cbranch_scc1 K_FIN
  s_mov_b32 s32, s68
  s_and_b32 s33, s69, 0xffff
  s_mov_b32 s34, 1835008
  s_mov_b32 s35, 0x20000
  s_mov_b32 s38, 0
  s_mov_b32 s40, 212992
  s_mov_b64 exec, 3
P2_36:
  buffer_load_dword v9, v7, s[28:31], s40 offen sc1
  s_waitcnt vmcnt(0)
  v_cmp_gt_u32 vcc, 1, v9
  s_nop 0
  s_cmp_eq_u64 vcc, 0
  s_cbranch_scc1 P2_36D
  s_sleep 4
  s_add_u32 s38, s38, 1
  s_cmp_lt_u32 s38, 60000
  s_cbranch_scc1 P2_36
P2_36D:
  s_mov_b64 exec, -1
  s_add_u32 s37, s11, 0
  buffer_load_dwordx4 v[80:83], v12, s[28:31], s37 offen sc1
  s_add_u32 s37, s11, 1024
  buffer_load_dwordx4 v[84:87], v12, s[28:31], s37 offen sc1
  s_add_u32 s37, s11, 2048
  buffer_load_dwordx4 v[88:91], v12, s[28:31], s37 offen sc1
  s_add_u32 s37, s11, 3072
  buffer_load_dwordx4 v[92:95], v12, s[28:31], s37 offen sc1
  s_add_u32 s37, s11, 4096
  buffer_load_dwordx4 v[96:99], v12, s[28:31], s37 offen sc1
  s_add_u32 s37, s11, 5120
  buffer_load_dwordx4 v[100:103], v12, s[28:31], s37 offen sc1
  s_add_u32 s37, s11, 6144
  buffer_load_dwordx4 v[104:107], v12, s[28:31], s37 offen sc1
  s_add_u32 s37, s11, 7168
  buffer_load_dwordx4 v[108:111], v12, s[28:31], s37 offen sc1
  s_add_u32 s37, s11, 8192
  buffer_load_dwordx4 v[112:115], v12, s[28:31], s37 offen sc1
  s_add_u32 s37, s11, 9216
  buffer_load_dwordx4 v[116:119], v12, s[28:31], s37 offen sc1
  s_add_u32 s37, s11, 10240
  buffer_load_dwordx4 v[120:123], v12, s[28:31], s37 offen sc1
  s_add_u32 s37, s11, 11264
  buffer_load_dwordx4 v[124:127], v12, s[28:31], s37 offen sc1
  s_add_u32 s37, s11, 12288
  buffer_load_dwordx4 v[128:131], v12, s[28:31], s37 offen sc1
  s_add_u32 s37, s11, 13312
  buffer_load_dwordx4 v[132:135], v12, s[28:31], s37 offen sc1
  v_lshrrev_b32 v3, 3, v2
  v_lshlrev_b32 v3, 6, v3
  v_and_b32 v4, 3, v2
  v_lshl_add_u32 v3, v4, 4, v3
  v_bfe_u32 v4, v2, 2, 1
  v_mul_u32_u24 v4, 917504, v4
  v_add_u32 v3, v3, v4
  s_lshl_b32 s13, s21, 6
  s_lshl_b32 s37, s3, 3
  s_add_u32 s13, s13, s37
  s_lshl_b32 s13, s13, 6
  s_mul_i32 s37, s17, 28672
  s_add_u32 s13, s13, s37
  s_add_u32 s13, s13, 1048576
  s_lshl_b32 s37, s3, 10
  s_add_u32 m0, s37, 139264
  s_lshr_b32 s15, s3, 1
  s_and_b32 s19, s3, 1
  v_lshrrev_b32 v13, 4, v2
  s_lshl_b32 s37, s15, 2
  v_add_u32 v13, s37, v13
  v_lshlrev_b32 v8, 4, v13
  s_lshl_b32 s16, s21, 8
  s_add_u32 s16, s16, 25344
  buffer_load_dwordx4 v[136:139], v8, s[28:31], s16 offen sc1
  v_and_b32 v14, 31, v2
  s_movk_i32 s18, 272
  v_mul_lo_u32 v14, v14, s18
  v_lshl_add_u32 v14, v5, 4, v14
  s_mul_i32 s18, s3, 17408
  v_add_u32 v14, s18, v14
  v_and_b32 v10, 15, v2
  s_lshl_b32 s18, s19, 4
  v_add_u32 v10, s18, v10
  v_mul_u32_u24 v140, 272, v10
  v_add_u32 v140, v140, v8
  v_add_u32 v141, 69632, v140
  v_bfe_u32 v11, v2, 2, 2
  v_lshl_add_u32 v11, v13, 2, v11
  v_lshlrev_b32 v11, 7, v11
  v_and_b32 v15, 3, v2
  v_lshl_add_u32 v11, v15, 3, v11
  s_lshl_b32 s18, s19, 5
  s_add_u32 s18, s18, 139264
  v_add_u32 v142, s18, v11
  v_mul_u32_u24 v143, 896, v10
  v_lshl_add_u32 v143, v13, 3, v143
  s_mul_i32 s10, s17, 28672
  s_lshl_b32 s18, s21, 7
  s_add_u32 s10, s10, s18
  v_mov_b32 v16, 0
  v_mov_b32 v17, 0
  v_mov_b32 v18, 0
  v_mov_b32 v19, 0
  v_mov_b32 v20, 0
  v_mov_b32 v21, 0
  v_mov_b32 v22, 0
  v_mov_b32 v23, 0
  v_mov_b32 v24, 0
  v_mov_b32 v25, 0
  v_mov_b32 v26, 0
  v_mov_b32 v27, 0
  v_mov_b32 v28, 0
  v_mov_b32 v29, 0
  v_mov_b32 v30, 0
  v_mov_b32 v31, 0
  v_mov_b32 v32, 0
  v_mov_b32 v33, 0
  v_mov_b32 v34, 0
  v_mov_b32 v35, 0
  v_mov_b32 v36, 0
  v_mov_b32 v37, 0
  v_mov_b32 v38, 0
  v_mov_b32 v39, 0
  v_mov_b32 v40, 0
  v_mov_b32 v41, 0
  v_mov_b32 v42, 0
  v_mov_b32 v43, 0
  v_mov_b32 v44, 0
  v_mov_b32 v45, 0
  v_mov_b32 v46, 0
  v_mov_b32 v47, 0
  v_mov_b32 v48, 0
  v_mov_b32 v49, 0
  v_mov_b32 v50, 0
  v_mov_b32 v51, 0
  v_mov_b32 v52, 0
  v_mov_b32 v53, 0
  v_mov_b32 v54, 0
  v_mov_b32 v55, 0
  v_mov_b32 v56, 0
  v_mov_b32 v57, 0
  v_mov_b32 v58, 0
  v_mov_b32 v59, 0
  v_mov_b32 v60, 0
  v_mov_b32 v61, 0
  v_mov_b32 v62, 0
  v_mov_b32 v63, 0
  v_mov_b32 v64, 0
  v_mov_b32 v65, 0
  v_mov_b32 v66, 0
  v_mov_b32 v67, 0
  v_mov_b32 v68, 0
  v_mov_b32 v69, 0
  v_mov_b32 v70, 0
  v_mov_b32 v71, 0
  v_mov_b32 v72, 0
  v_mov_b32 v73, 0
  v_mov_b32 v74, 0
  v_mov_b32 v75, 0
  v_mov_b32 v76, 0
  v_mov_b32 v77, 0
  v_mov_b32 v78, 0
  v_mov_b32 v79, 0
  s_mov_b32 s38, 0
  s_mov_b32 s40, 196608
  s_mov_b64 exec, 3
P2_37:
  buffer_load_dword v9, v7, s[28:31], s40 offen sc1
  s_waitcnt vmcnt(0)
  v_cmp_gt_u32 vcc, 1, v9
  s_nop 0
  s_cmp_eq_u64 vcc, 0
  s_cbranch_scc1 P2_37D
  s_sleep 4
  s_add_u32 s38, s38, 1
  s_cmp_lt_u32 s38, 60000
  s_cbranch_scc1 P2_37
P2_37D:
  s_mov_b64 exec, -1
  v_mfma_f32_32x32x16_bf16 v[16:31], v[144:147], v[80:83], v[16:31]
  v_mfma_f32_32x32x16_bf16 v[48:63], v[148:151], v[80:83], v[48:63]
  s_barrier
  buffer_load_dwordx4 v3, s[28:31], s13 offen sc1 lds
  s_add_u32 s37, s11, 3670016
  buffer_load_dwordx4 v[80:83], v12, s[28:31], s37 offen sc1
  v_mfma_f32_32x32x16_bf16 v[16:31], v[152:155], v[84:87], v[16:31]
  v_mfma_f32_32x32x16_bf16 v[48:63], v[156:159], v[84:87], v[48:63]
  s_add_u32 s37, s11, 3671040
  buffer_load_dwordx4 v[84:87], v12, s[28:31], s37 offen sc1
  v_mfma_f32_32x32x16_bf16 v[16:31], v[160:163], v[88:91], v[16:31]
  v_mfma_f32_32x32x16_bf16 v[48:63], v[164:167], v[88:91], v[48:63]
  s_add_u32 s37, s11, 3672064
  buffer_load_dwordx4 v[88:91], v12, s[28:31], s37 offen sc1
  v_mfma_f32_32x32x16_bf16 v[16:31], v[168:171], v[92:95], v[16:31]
  v_mfma_f32_32x32x16_bf16 v[48:63], v[172:175], v[92:95], v[48:63]
  s_add_u32 s37, s11, 3673088
  buffer_load_dwordx4 v[92:95], v12, s[28:31], s37 offen sc1
  v_mfma_f32_32x32x16_bf16 v[16:31], v[176:179], v[96:99], v[16:31]
  v_mfma_f32_32x32x16_bf16 v[48:63], v[180:183], v[96:99], v[48:63]
  s_add_u32 s37, s11, 3674112
  buffer_load_dwordx4 v[96:99], v12, s[28:31], s37 offen sc1
  v_mfma_f32_32x32x16_bf16 v[16:31], v[184:187], v[100:103], v[16:31]
  v_mfma_f32_32x32x16_bf16 v[48:63], v[188:191], v[100:103], v[48:63]
  s_add_u32 s37, s11, 3675136
  buffer_load_dwordx4 v[100:103], v12, s[28:31], s37 offen sc1
  v_mfma_f32_32x32x16_bf16 v[16:31], v[192:195], v[104:107], v[16:31]
  v_mfma_f32_32x32x16_bf16 v[48:63], v[196:199], v[104:107], v[48:63]
  s_add_u32 s37, s11, 3676160
  buffer_load_dwordx4 v[104:107], v12, s[28:31], s37 offen sc1
  v_mfma_f32_32x32x16_bf16 v[16:31], v[200:203], v[108:111], v[16:31]
  v_mfma_f32_32x32x16_bf16 v[48:63], v[204:207], v[108:111], v[48:63]
  s_add_u32 s37, s11, 3677184
  buffer_load_dwordx4 v[108:111], v12, s[28:31], s37 offen sc1
  v_mfma_f32_32x32x16_bf16 v[16:31], v[208:211], v[112:115], v[16:31]
  v_mfma_f32_32x32x16_bf16 v[48:63], v[212:215], v[112:115], v[48:63]
  s_add_u32 s37, s11, 3678208
  buffer_load_dwordx4 v[112:115], v12, s[28:31], s37 offen sc1
  v_mfma_f32_32x32x16_bf16 v[16:31], v[216:219], v[116:119], v[16:31]
  v_mfma_f32_32x32x16_bf16 v[48:63], v[220:223], v[116:119], v[48:63]
  s_add_u32 s37, s11, 3679232
  buffer_load_dwordx4 v[116:119], v12, s[28:31], s37 offen sc1
  v_mfma_f32_32x32x16_bf16 v[16:31], v[224:227], v[120:123], v[16:31]
  v_mfma_f32_32x32x16_bf16 v[48:63], v[228:231], v[120:123], v[48:63]
  s_add_u32 s37, s11, 3680256
  buffer_load_dwordx4 v[120:123], v12, s[28:31], s37 offen sc1
  v_mfma_f32_32x32x16_bf16 v[16:31], v[232:235], v[124:127], v[16:31]
  v_mfma_f32_32x32x16_bf16 v[48:63], v[236:239], v[124:127], v[48:63]
  s_add_u32 s37, s11, 3681280
  buffer_load_dwordx4 v[124:127], v12, s[28:31], s37 offen sc1
  v_mfma_f32_32x32x16_bf16 v[16:31], v[240:243], v[128:131], v[16:31]
  v_mfma_f32_32x32x16_bf16 v[48:63], v[244:247], v[128:131], v[48:63]
  s_add_u32 s37, s11, 3682304
  buffer_load_dwordx4 v[128:131], v12, s[28:31], s37 offen sc1
  v_mfma_f32_32x32x16_bf16 v[16:31], v[248:251], v[132:135], v[16:31]
  v_mfma_f32_32x32x16_bf16 v[48:63], v[252:255], v[132:135], v[48:63]
  s_add_u32 s37, s11, 3683328
  buffer_load_dwordx4 v[132:135], v12, s[28:31], s37 offen sc1
  s_nop 8
  ds_write_b128 v14, v[16:19] offset:0
  ds_write_b128 v14, v[20:23] offset:32
  ds_write_b128 v14, v[24:27] offset:64
  ds_write_b128 v14, v[28:31] offset:96
  ds_write_b128 v14, v[48:51] offset:128
  ds_write_b128 v14, v[52:55] offset:160
  ds_write_b128 v14, v[56:59] offset:192
  ds_write_b128 v14, v[60:63] offset:224
  s_waitcnt vmcnt(14) lgkmcnt(0)
  s_barrier
  ds_read_b64_tr_b16 v[10:11], v142 offset:0
  ds_read_b128 v[16:19], v140 offset:0
  ds_read_b128 v[20:23], v140 offset:17408
  ds_read_b128 v[24:27], v140 offset:34816
  ds_read_b128 v[28:31], v140 offset:52224
  ds_read_b128 v[48:51], v141 offset:0
  ds_read_b128 v[52:55], v141 offset:17408
  ds_read_b128 v[56:59], v141 offset:34816
  ds_read_b128 v[60:63], v141 offset:52224
  s_waitcnt lgkmcnt(6)
  v_add_f32 v16, v16, v20
  v_add_f32 v17, v17, v21
  v_add_f32 v18, v18, v22
  v_add_f32 v19, v19, v23
  s_waitcnt lgkmcnt(5)
  v_add_f32 v16, v16, v24
  v_add_f32 v17, v17, v25
  v_add_f32 v18, v18, v26
  v_add_f32 v19, v19, v27
  s_waitcnt lgkmcnt(4)
  v_add_f32 v16, v16, v28
  v_add_f32 v17, v17, v29
  v_add_f32 v18, v18, v30
  v_add_f32 v19, v19, v31
  s_waitcnt lgkmcnt(3)
  v_add_f32 v16, v16, v48
  v_add_f32 v17, v17, v49
  v_add_f32 v18, v18, v50
  v_add_f32 v19, v19, v51
  s_waitcnt lgkmcnt(2)
  v_add_f32 v16, v16, v52
  v_add_f32 v17, v17, v53
  v_add_f32 v18, v18, v54
  v_add_f32 v19, v19, v55
  s_waitcnt lgkmcnt(1)
  v_add_f32 v16, v16, v56
  v_add_f32 v17, v17, v57
  v_add_f32 v18, v18, v58
  v_add_f32 v19, v19, v59
  s_waitcnt lgkmcnt(0)
  v_add_f32 v16, v16, v60
  v_add_f32 v17, v17, v61
  v_add_f32 v18, v18, v62
  v_add_f32 v19, v19, v63
  v_cvt_pk_bf16_f32 v22, v16, v17
  v_lshlrev_b32 v20, 16, v22
  v_and_b32 v21, 0xffff0000, v22
  v_mul_f32 v20, v20, v136
  v_mul_f32 v21, v21, v137
  v_cvt_pk_bf16_f32 v22, v20, v21
  v_lshlrev_b32 v20, 16, v22
  v_and_b32 v21, 0xffff0000, v22
  v_lshlrev_b32 v22, 16, v10
  v_and_b32 v23, 0xffff0000, v10
  v_add_f32 v20, v20, v22
  v_add_f32 v21, v21, v23
  v_cvt_pk_bf16_f32 v8, v20, v21
  v_cvt_pk_bf16_f32 v30, v18, v19
  v_lshlrev_b32 v28, 16, v30
  v_and_b32 v29, 0xffff0000, v30
  v_mul_f32 v28, v28, v138
  v_mul_f32 v29, v29, v139
  v_cvt_pk_bf16_f32 v30, v28, v29
  v_lshlrev_b32 v28, 16, v30
  v_and_b32 v29, 0xffff0000, v30
  v_lshlrev_b32 v30, 16, v11
  v_and_b32 v31, 0xffff0000, v11
  v_add_f32 v28, v28, v30
  v_add_f32 v29, v29, v31
  v_cvt_pk_bf16_f32 v9, v28, v29
  s_add_u32 s37, s10, 0
  buffer_store_dwordx2 v[8:9], v143, s[32:35], s37 offen
  s_waitcnt vmcnt(14)
  v_mfma_f32_32x32x16_bf16 v[32:47], v[144:147], v[80:83], v[32:47]
  v_mfma_f32_32x32x16_bf16 v[64:79], v[148:151], v[80:83], v[64:79]
  s_waitcnt vmcnt(13)
  v_mfma_f32_32x32x16_bf16 v[32:47], v[152:155], v[84:87], v[32:47]
  v_mfma_f32_32x32x16_bf16 v[64:79], v[156:159], v[84:87], v[64:79]
  s_waitcnt vmcnt(12)
  v_mfma_f32_32x32x16_bf16 v[32:47], v[160:163], v[88:91], v[32:47]
  v_mfma_f32_32x32x16_bf16 v[64:79], v[164:167], v[88:91], v[64:79]
  s_waitcnt vmcnt(11)
  v_mfma_f32_32x32x16_bf16 v[32:47], v[168:171], v[92:95], v[32:47]
  v_mfma_f32_32x32x16_bf16 v[64:79], v[172:175], v[92:95], v[64:79]
  s_waitcnt vmcnt(10)
  v_mfma_f32_32x32x16_bf16 v[32:47], v[176:179], v[96:99], v[32:47]
  v_mfma_f32_32x32x16_bf16 v[64:79], v[180:183], v[96:99], v[64:79]
  s_waitcnt vmcnt(9)
  v_mfma_f32_32x32x16_bf16 v[32:47], v[184:187], v[100:103], v[32:47]
  v_mfma_f32_32x32x16_bf16 v[64:79], v[188:191], v[100:103], v[64:79]
  s_waitcnt vmcnt(8)
  v_mfma_f32_32x32x16_bf16 v[32:47], v[192:195], v[104:107], v[32:47]
  v_mfma_f32_32x32x16_bf16 v[64:79], v[196:199], v[104:107], v[64:79]
  s_waitcnt vmcnt(7)
  v_mfma_f32_32x32x16_bf16 v[32:47], v[200:203], v[108:111], v[32:47]
  v_mfma_f32_32x32x16_bf16 v[64:79], v[204:207], v[108:111], v[64:79]
  s_waitcnt vmcnt(6)
  v_mfma_f32_32x32x16_bf16 v[32:47], v[208:211], v[112:115], v[32:47]
  v_mfma_f32_32x32x16_bf16 v[64:79], v[212:215], v[112:115], v[64:79]
  s_waitcnt vmcnt(5)
  v_mfma_f32_32x32x16_bf16 v[32:47], v[216:219], v[116:119], v[32:47]
  v_mfma_f32_32x32x16_bf16 v[64:79], v[220:223], v[116:119], v[64:79]
  s_waitcnt vmcnt(4)
  v_mfma_f32_32x32x16_bf16 v[32:47], v[224:227], v[120:123], v[32:47]
  v_mfma_f32_32x32x16_bf16 v[64:79], v[228:231], v[120:123], v[64:79]
  s_waitcnt vmcnt(3)
  v_mfma_f32_32x32x16_bf16 v[32:47], v[232:235], v[124:127], v[32:47]
  v_mfma_f32_32x32x16_bf16 v[64:79], v[236:239], v[124:127], v[64:79]
  s_waitcnt vmcnt(2)
  v_mfma_f32_32x32x16_bf16 v[32:47], v[240:243], v[128:131], v[32:47]
  v_mfma_f32_32x32x16_bf16 v[64:79], v[244:247], v[128:131], v[64:79]
  s_waitcnt vmcnt(1)
  v_mfma_f32_32x32x16_bf16 v[32:47], v[248:251], v[132:135], v[32:47]
  v_mfma_f32_32x32x16_bf16 v[64:79], v[252:255], v[132:135], v[64:79]
  s_nop 10
  ds_write_b128 v14, v[32:35] offset:8704
  ds_write_b128 v14, v[36:39] offset:8736
  ds_write_b128 v14, v[40:43] offset:8768
  ds_write_b128 v14, v[44:47] offset:8800
  ds_write_b128 v14, v[64:67] offset:8832
  ds_write_b128 v14, v[68:71] offset:8864
  ds_write_b128 v14, v[72:75] offset:8896
  ds_write_b128 v14, v[76:79] offset:8928
  s_waitcnt lgkmcnt(0)
  s_barrier
  ds_read_b64_tr_b16 v[10:11], v142 offset:64
  ds_read_b128 v[32:35], v140 offset:8704
  ds_read_b128 v[36:39], v140 offset:26112
  ds_read_b128 v[40:43], v140 offset:43520
  ds_read_b128 v[44:47], v140 offset:60928
  ds_read_b128 v[64:67], v141 offset:8704
  ds_read_b128 v[68:71], v141 offset:26112
  ds_read_b128 v[72:75], v141 offset:43520
  ds_read_b128 v[76:79], v141 offset:60928
  s_waitcnt lgkmcnt(6)
  v_add_f32 v32, v32, v36
  v_add_f32 v33, v33, v37
  v_add_f32 v34, v34, v38
  v_add_f32 v35, v35, v39
  s_waitcnt lgkmcnt(5)
  v_add_f32 v32, v32, v40
  v_add_f32 v33, v33, v41
  v_add_f32 v34, v34, v42
  v_add_f32 v35, v35, v43
  s_waitcnt lgkmcnt(4)
  v_add_f32 v32, v32, v44
  v_add_f32 v33, v33, v45
  v_add_f32 v34, v34, v46
  v_add_f32 v35, v35, v47
  s_waitcnt lgkmcnt(3)
  v_add_f32 v32, v32, v64
  v_add_f32 v33, v33, v65
  v_add_f32 v34, v34, v66
  v_add_f32 v35, v35, v67
  s_waitcnt lgkmcnt(2)
  v_add_f32 v32, v32, v68
  v_add_f32 v33, v33, v69
  v_add_f32 v34, v34, v70
  v_add_f32 v35, v35, v71
  s_waitcnt lgkmcnt(1)
  v_add_f32 v32, v32, v72
  v_add_f32 v33, v33, v73
  v_add_f32 v34, v34, v74
  v_add_f32 v35, v35, v75
  s_waitcnt lgkmcnt(0)
  v_add_f32 v32, v32, v76
  v_add_f32 v33, v33, v77
  v_add_f32 v34, v34, v78
  v_add_f32 v35, v35, v79
  v_cvt_pk_bf16_f32 v38, v32, v33
  v_lshlrev_b32 v36, 16, v38
  v_and_b32 v37, 0xffff0000, v38
  v_mul_f32 v36, v36, v136
  v_mul_f32 v37, v37, v137
  v_cvt_pk_bf16_f32 v38, v36, v37
  v_lshlrev_b32 v36, 16, v38
  v_and_b32 v37, 0xffff0000, v38
  v_lshlrev_b32 v38, 16, v10
  v_and_b32 v39, 0xffff0000, v10
  v_add_f32 v36, v36, v38
  v_add_f32 v37, v37, v39
  v_cvt_pk_bf16_f32 v8, v36, v37
  v_cvt_pk_bf16_f32 v46, v34, v35
  v_lshlrev_b32 v44, 16, v46
  v_and_b32 v45, 0xffff0000, v46
  v_mul_f32 v44, v44, v138
  v_mul_f32 v45, v45, v139
  v_cvt_pk_bf16_f32 v46, v44, v45
  v_lshlrev_b32 v44, 16, v46
  v_and_b32 v45, 0xffff0000, v46
  v_lshlrev_b32 v46, 16, v11
  v_and_b32 v47, 0xffff0000, v11
  v_add_f32 v44, v44, v46
  v_add_f32 v45, v45, v47
  v_cvt_pk_bf16_f32 v9, v44, v45
  s_add_u32 s37, s10, 917504
  buffer_store_dwordx2 v[8:9], v143, s[32:35], s37 offen
K_FIN:
K_END:
  s_endpgm

.section .rodata,"a"
.p2align 6
.amdhsa_kernel adaLN_cond__ssm_conv_s4d__glu_gated_swiglu__prompt_kernel
  .amdhsa_next_free_vgpr 256
  .amdhsa_next_free_sgpr 102
  .amdhsa_accum_offset 256
  .amdhsa_group_segment_fixed_size 0
  .amdhsa_kernarg_size 128
  .amdhsa_user_sgpr_count 2
  .amdhsa_user_sgpr_kernarg_segment_ptr 1
  .amdhsa_system_sgpr_workgroup_id_x 1
  .amdhsa_float_denorm_mode_32 3
  .amdhsa_float_denorm_mode_16_64 3
.end_amdhsa_kernel
```
